```python
import torch

def _softmax(x, axis=-1):
    return torch.softmax(x, dim=axis)
def _gelu(x):
    return torch.nn.functional.gelu(x, approximate="tanh")
def _silu(x):
    return torch.nn.functional.silu(x)
def _sigmoid(x):
    return torch.sigmoid(x)
def _layernorm(x, axis=-1, eps=1e-5):
    m = x.mean(dim=axis, keepdim=True)
    v = x.var(dim=axis, keepdim=True, unbiased=False)
    return (x - m) / torch.sqrt(v + eps)
def _scatter_add(tgt, idx, src, axis=0):
    return tgt.clone().index_add_(axis, idx, src)
def _segment_sum(src, seg, n):
    out = torch.zeros((n,) + src.shape[1:], dtype=src.dtype)
    return out.index_add_(0, seg, src)
def _pad(x, pw):
    flat = tuple(v for pair in reversed(pw) for v in pair)
    return torch.nn.functional.pad(x, flat)

kernel_name = 'gated_mix__ssm_conv_s4__glu_gated_reglu__prompt'

def setup_inputs():

    _w = (lambda a: (lambda t: t.to(torch.bfloat16) if t.is_floating_point() else t)(torch.as_tensor(a)))
    def _A_setup():
        B, L, D, N = 1, 2048, 512, 128
        A_re = -(lambda _x: torch.exp(torch.as_tensor(_x)))((lambda *s: torch.randn(*s, dtype=torch.bfloat16) * 6.4)(D, N))
        A_im = torch.pi * (lambda *s: torch.randn(*s, dtype=torch.bfloat16) * 0.05)(D, N)
        B_re = (lambda *s: torch.randn(*s, dtype=torch.bfloat16) * 0.1)(D, N)
        B_im = (lambda *s: torch.randn(*s, dtype=torch.bfloat16) * 0.1)(D, N)
        C_re = (lambda *s: torch.randn(*s, dtype=torch.bfloat16) * 0.1)(D, N)
        C_im = (lambda *s: torch.randn(*s, dtype=torch.bfloat16) * 0.1)(D, N)
        log_dt = (lambda *s: torch.randn(*s, dtype=torch.bfloat16) * 0.05)(D) * 0.5 - 4.0
        Dskip = (lambda *s: torch.randn(*s, dtype=torch.bfloat16) * 0.05)(D)
        return {
            "u": _w((lambda *s: torch.randn(*s, dtype=torch.bfloat16) * 0.05)(B, L, D)),
            "A_re": _w(A_re),
            "A_im": _w(A_im),
            "B_re": _w(B_re),
            "B_im": _w(B_im),
            "C_re": _w(C_re),
            "C_im": _w(C_im),
            "log_dt": _w(log_dt),
            "Dskip": _w(Dskip),
        }
    _A_in = _A_setup()

    def _B_setup():
        B, S, D, F = 1, 2048, 512, 1376
        return {
            "x": _w((lambda *s: torch.randn(*s, dtype=torch.bfloat16) * 0.05)(B, S, D)),
            "W_gate": _w((lambda *s: torch.randn(*s, dtype=torch.bfloat16) * 0.8)(D, F) * (2.0 / D) ** 0.5),
            "W_up": _w((lambda *s: torch.randn(*s, dtype=torch.bfloat16) * 0.8)(D, F) * (2.0 / D) ** 0.5),
            "W_down": _w((lambda *s: torch.randn(*s, dtype=torch.bfloat16) * 0.8)(F, D) * (1.0 / F) ** 0.5),
        }
    _B_in = _B_setup()

    return {
        "A_u": _A_in["u"],
        "A_A_re": _A_in["A_re"],
        "A_A_im": _A_in["A_im"],
        "A_B_re": _A_in["B_re"],
        "A_B_im": _A_in["B_im"],
        "A_C_re": _A_in["C_re"],
        "A_C_im": _A_in["C_im"],
        "A_log_dt": _A_in["log_dt"],
        "A_Dskip": _A_in["Dskip"],
        "B_x": _B_in["x"],
        "B_W_gate": _B_in["W_gate"],
        "B_W_up": _B_in["W_up"],
        "B_W_down": _B_in["W_down"],
        "gate_w": _w((lambda *s: torch.randn(*s, dtype=torch.bfloat16) * 0.05)(512) * 16.0),
    }

def reference(A_u, A_A_re, A_A_im, A_B_re, A_B_im, A_C_re, A_C_im, A_log_dt, A_Dskip, B_x, B_W_gate, B_W_up, B_W_down, gate_w):
    def _A_ref(u, A_re, A_im, B_re, B_im, C_re, C_im, log_dt, Dskip):
        Bsz, L, D = u.shape
        dt = torch.exp(log_dt)[:, None]
        A = A_re + 1j * A_im
        Bc = B_re + 1j * B_im
        Cc = C_re + 1j * C_im
        logdA = dt * A
        dB = dt * Bc
        l = (lambda x, dt: x.to(dt))(torch.arange(L), A_re.dtype)
        P = torch.exp(logdA[:, :, None] * l[None, None, :])
        K = torch.einsum("dn,dnl,dn->dl", Cc, P, dB).real
        L2 = 2 * L
        Kp = _pad(K, ((0, 0), (0, L)))
        up = (lambda x, *d: x.permute(*d))(u, 0, 2, 1)
        up = _pad(up, ((0, 0), (0, 0), (0, L)))
        Kf = (lambda x, axes=(-2,-1): torch.fft.rfft2(x.float(), dim=axes))(Kp[:, None, :], axes=(-2, -1))
        Uf = (lambda x, axes=(-2,-1): torch.fft.rfft2(x.float(), dim=axes))(up[:, :, None, :], axes=(-2, -1))
        Yf = Uf * Kf[None, :, :, :]
        y = (lambda x, s, axes=(-2,-1): torch.fft.irfft2(x, s=s, dim=axes).to(torch.bfloat16))(Yf, (1, L2), axes=(-2, -1))[:, :, 0, :L]
        y = (lambda x, *d: x.permute(*d))(y, 0, 2, 1) + u * Dskip[None, None, :]
        return y

    def _B_ref(x, W_gate, W_up, W_down):
        gate = torch.einsum("bsd,df->bsf", x, W_gate)
        up = torch.einsum("bsd,df->bsf", x, W_up)
        gate = gate * (lambda x, dt: x.to(dt))(gate > 0, gate.dtype)
        h = gate * up
        return torch.einsum("bsf,fd->bsd", h, W_down)

    x = A_u
    g = _sigmoid((x * gate_w).sum(-1, keepdims=True))
    a = _A_ref(x, A_A_re, A_A_im, A_B_re, A_B_im, A_C_re, A_C_im, A_log_dt, A_Dskip)
    b = _B_ref(x, B_W_gate, B_W_up, B_W_down)
    return g * a + (1 - g) * b
```

```asm
; @launch grid=(512,1,1) block=(256,1,1) lds=81920
.amdgcn_target "amdgcn-amd-amdhsa--gfx950"
.text
.globl gated_mix__ssm_conv_s4__glu_gated_reglu__prompt_kernel
.p2align 8
.type gated_mix__ssm_conv_s4__glu_gated_reglu__prompt_kernel,@function
gated_mix__ssm_conv_s4__glu_gated_reglu__prompt_kernel:
    s_cmp_ge_u32 s2, 512
    s_cbranch_scc1 L_end
    s_cmp_lg_u32 s2, 0
    s_cbranch_scc1 L_nn
    v_cmp_eq_u32 vcc, 0, v0
    s_cbranch_vccz L_nn
    s_load_dwordx2 s[4:5], s[0:1], 120
    s_memrealtime s[6:7]
    v_mov_b32 v3, 0
    s_waitcnt lgkmcnt(0)
    s_or_b32 s6, s6, 1
    v_mov_b32 v4, s6
    v_mov_b32 v5, s7
    s_mov_b64 exec, 1
    global_store_dwordx2 v3, v[4:5], s[4:5] sc1
    s_mov_b64 exec, -1
L_nn:
    s_cmp_ge_u32 s2, 16
    s_cbranch_scc1 L_ncp
    s_getpc_b64 s[10:11]
L_pc:
    v_lshlrev_b32 v217, 6, v0
    s_mov_b32 s12, L_end-L_pc
    v_cmp_gt_u32 vcc, s12, v217
    s_and_saveexec_b64 s[14:15], vcc
    global_load_dword v216, v217, s[10:11]
    s_mov_b64 exec, s[14:15]
    v_add_u32 v217, 16384, v217
    v_cmp_gt_u32 vcc, s12, v217
    s_and_saveexec_b64 s[14:15], vcc
    s_cbranch_execz L_ncp2
    global_load_dword v216, v217, s[10:11]
L_ncp2:
    s_mov_b64 exec, s[14:15]
L_ncp:
    s_xor_b32 s2, s2, 256
    s_cmp_ge_u32 s2, 256
    s_cbranch_scc1 L_q
    s_load_dwordx2 s[4:5], s[0:1], 0
    s_load_dwordx2 s[6:7], s[0:1], 80
    s_load_dwordx2 s[8:9], s[0:1], 88
    s_load_dwordx4 s[44:47], s[0:1], 112
    s_load_dwordx2 s[10:11], s[0:1], 128
    s_and_b32 s30, s2, 7
    s_lshr_b32 s31, s2, 3
    s_lshr_b32 s26, s30, 1
    s_lshl_b32 s26, s26, 2
    s_and_b32 s32, s31, 3
    s_add_u32 s26, s26, s32
    s_and_b32 s25, s30, 1
    s_lshl_b32 s25, s25, 3
    s_lshr_b32 s32, s31, 2
    s_add_u32 s25, s25, s32
    v_lshrrev_b32 v12, 6, v0
    v_and_b32 v13, 63, v0
    s_mov_b32 s29, 0
    v_readfirstlane_b32 s24, v12
    s_lshr_b32 s32, s31, 2
    s_cmp_lg_u32 s32, 7
    s_cbranch_scc1 M2_2
    s_bfe_u32 s29, s31, 0x10001
    s_and_b32 s32, s30, 1
    s_lshl_b32 s32, s32, 1
    s_add_u32 s26, s26, s32
    s_mov_b32 s25, 7
M2_2:
    s_and_b32 s30, s24, 1
    s_mul_i32 s30, s30, 192
    s_mul_i32 s31, s25, 192
    s_mov_b32 s33, 2752
    s_mov_b32 s34, 0xaaab
    s_cmp_eq_u32 s25, 14
    s_cselect_b32 s37, 64, 0x10000
    v_mov_b32 v17, 0x8000000
    v_add_u32 v14, s30, v13
    v_mul_lo_u32 v15, v14, s34
    v_lshrrev_b32 v15, 19, v15
    v_mul_u32_u24 v16, 12, v15
    v_sub_u32 v16, v14, v16
    v_lshlrev_b32 v16, 4, v16
    v_mul_lo_u32 v15, v15, s33
    v_add_u32 v15, v15, v16
    v_add_u32 v6, s31, v15
    v_cmp_le_u32 vcc, s37, v16
    s_nop 1
    v_cndmask_b32 v6, v6, v17, vcc
    v_add_u32 v14, s30, v13
    v_add_u32 v14, 64, v14
    v_mul_lo_u32 v15, v14, s34
    v_lshrrev_b32 v15, 19, v15
    v_mul_u32_u24 v16, 12, v15
    v_sub_u32 v16, v14, v16
    v_lshlrev_b32 v16, 4, v16
    v_mul_lo_u32 v15, v15, s33
    v_add_u32 v15, v15, v16
    v_add_u32 v7, s31, v15
    v_subrev_u32 v7, 1024, v7
    v_cmp_le_u32 vcc, s37, v16
    s_nop 1
    v_cndmask_b32 v7, v7, v17, vcc
    v_add_u32 v14, s30, v13
    v_add_u32 v14, 128, v14
    v_mul_lo_u32 v15, v14, s34
    v_lshrrev_b32 v15, 19, v15
    v_mul_u32_u24 v16, 12, v15
    v_sub_u32 v16, v14, v16
    v_lshlrev_b32 v16, 4, v16
    v_mul_lo_u32 v15, v15, s33
    v_add_u32 v15, v15, v16
    v_add_u32 v8, s31, v15
    v_subrev_u32 v8, 2048, v8
    v_cmp_le_u32 vcc, s37, v16
    s_nop 1
    v_cndmask_b32 v8, v8, v17, vcc
    s_lshl_b32 s30, s26, 7
    s_lshl_b32 s31, s24, 5
    s_add_u32 s30, s30, s31
    s_lshl_b32 s30, s30, 10
    v_lshrrev_b32 v14, 3, v13
    v_lshlrev_b32 v14, 10, v14
    v_add_u32 v14, s30, v14
    v_lshrrev_b32 v15, 4, v13
    v_and_b32 v16, 7, v13
    v_xor_b32 v17, v16, v15
    v_lshlrev_b32 v17, 4, v17
    v_add_u32 v9, v14, v17
    v_or_b32 v15, 4, v15
    v_xor_b32 v17, v16, v15
    v_lshlrev_b32 v17, 4, v17
    v_add_u32 v10, v14, v17
    v_add_u32 v10, 7168, v10
    s_mul_i32 s35, s24, 3072
    s_lshl_b32 s36, s24, 12
    s_add_u32 s36, s36, 49152
    s_memrealtime s[42:43]
    s_waitcnt lgkmcnt(0)
    s_mov_b32 s12, s4
    s_mov_b32 s13, s5
    s_mov_b32 s14, 2097152
    s_mov_b32 s15, 0x00020000
    s_cmp_ge_u32 s24, 2
    s_cselect_b32 s6, s8, s6
    s_cselect_b32 s7, s9, s7
    s_mov_b32 s16, s6
    s_mov_b32 s17, s7
    s_mov_b32 s18, 1409024
    s_mov_b32 s19, 0x00020000
    s_cmp_lg_u32 s29, 0
    s_cbranch_scc1 Pnold_3
    s_add_u32 m0, s36, 0
    s_mov_b32 s28, 0
    buffer_load_dwordx4 v9, s[12:15], s28 offen offset:0 lds
    buffer_load_dwordx4 v10, s[12:15], s28 offen offset:1024 lds
    s_mov_b32 s28, 14336
    s_nop 0
    buffer_load_dwordx4 v9, s[12:15], s28 offen offset:2048 lds
    buffer_load_dwordx4 v10, s[12:15], s28 offen offset:3072 lds
    s_add_u32 m0, s35, 0
    s_mov_b32 s27, 0
    buffer_load_dwordx4 v6, s[16:19], s27 offen offset:0 lds
    buffer_load_dwordx4 v7, s[16:19], s27 offen offset:1024 lds
    buffer_load_dwordx4 v8, s[16:19], s27 offen offset:2048 lds
    s_add_u32 m0, s35, 12288
    s_mov_b32 s27, 88064
    buffer_load_dwordx4 v6, s[16:19], s27 offen offset:0 lds
    buffer_load_dwordx4 v7, s[16:19], s27 offen offset:1024 lds
    buffer_load_dwordx4 v8, s[16:19], s27 offen offset:2048 lds
    s_add_u32 m0, s36, 16384
    s_mov_b32 s28, 128
    buffer_load_dwordx4 v9, s[12:15], s28 offen offset:0 lds
    buffer_load_dwordx4 v10, s[12:15], s28 offen offset:1024 lds
    s_mov_b32 s28, 14464
    s_nop 0
    buffer_load_dwordx4 v9, s[12:15], s28 offen offset:2048 lds
    buffer_load_dwordx4 v10, s[12:15], s28 offen offset:3072 lds
    s_add_u32 m0, s35, 24576
    s_mov_b32 s27, 176128
    buffer_load_dwordx4 v6, s[16:19], s27 offen offset:0 lds
    buffer_load_dwordx4 v7, s[16:19], s27 offen offset:1024 lds
    buffer_load_dwordx4 v8, s[16:19], s27 offen offset:2048 lds
Pnold_3:
    s_branch Pnn_4
    s_cmp_lg_u32 s2, 240
    s_cbranch_scc1 Pnn_4
    s_cmp_lg_u32 s24, 0
    s_cbranch_scc1 Pnn_4
    s_or_b32 s42, s42, 1
    v_mov_b32 v14, s42
    v_mov_b32 v15, s43
    v_mov_b32 v16, 0
    s_mov_b64 exec, 1
    global_store_dwordx2 v16, v[14:15], s[46:47] sc1
    s_mov_b64 exec, -1
Pnn_4:
    s_mov_b32 s20, s10
    s_mov_b32 s21, s11
    s_mov_b32 s22, 5636096
    s_mov_b32 s23, 0x00020000
    s_mov_b32 s48, s10
    s_mov_b32 s49, s11
    s_mov_b32 s50, 14680064
    s_mov_b32 s51, 0x00020000
    s_mov_b32 s52, s44
    s_mov_b32 s53, s45
    s_mov_b32 s54, 2097152
    s_mov_b32 s55, 0x00020000
    v_lshrrev_b32 v14, 5, v13
    v_lshlrev_b32 v14, 3, v14
    v_bfe_u32 v15, v13, 2, 2
    v_add_u32 v14, v14, v15
    v_mul_u32_u24 v14, 192, v14
    v_bfe_u32 v15, v13, 4, 1
    v_lshlrev_b32 v15, 5, v15
    v_and_b32 v16, 3, v13
    v_lshlrev_b32 v16, 3, v16
    v_add3_u32 v1, v14, v15, v16
    v_and_b32 v14, 31, v13
    v_bfe_u32 v15, v13, 1, 3
    v_lshrrev_b32 v16, 5, v13
    v_xor_b32 v15, v15, v16
    v_lshlrev_b32 v14, 7, v14
    s_lshl_b32 s30, s24, 12
    s_add_u32 s30, s30, 49152
    v_add_u32 v14, s30, v14
    v_xor_b32 v16, 0, v15
    v_lshlrev_b32 v16, 4, v16
    v_add_u32 v2, v14, v16
    v_xor_b32 v16, 2, v15
    v_lshlrev_b32 v16, 4, v16
    v_add_u32 v3, v14, v16
    v_xor_b32 v16, 4, v15
    v_lshlrev_b32 v16, 4, v16
    v_add_u32 v4, v14, v16
    v_xor_b32 v16, 6, v15
    v_lshlrev_b32 v16, 4, v16
    v_add_u32 v5, v14, v16
    s_lshl_b32 s30, s26, 2
    s_add_u32 s30, s30, s24
    s_mul_i32 s31, s30, 86
    s_mul_i32 s32, s25, 6
    s_add_u32 s31, s31, s32
    s_lshl_b32 s31, s31, 10
    v_lshlrev_b32 v50, 4, v13
    v_add_u32 v11, s31, v50
    s_lshl_b32 s30, s30, 4
    s_add_u32 s30, s30, s25
    s_lshl_b32 s30, s30, 7
    s_add_u32 s30, s30, 5832704
    v_mov_b32 v58, s30
    v_mov_b32 v59, 0
    s_and_b32 s30, s2, 7
    s_lshr_b32 s31, s2, 3
    s_lshl_b32 s56, s30, 3
    s_and_b32 s57, s31, 3
    s_lshl_b32 s57, s57, 1
    s_add_u32 s38, s56, s57
    s_lshr_b32 s39, s31, 2
    s_lshl_b32 s40, s39, 1
    s_mul_i32 s56, s24, 22
    s_cmp_eq_u32 s24, 3
    s_cselect_b32 s57, 1, 0
    s_sub_u32 s41, s56, s57
    s_and_b32 s57, s24, 1
    s_lshr_b32 s58, s24, 1
    s_add_u32 s60, s40, s57
    s_add_u32 s61, s38, s58
    s_xor_b32 s62, s60, 1
    s_xor_b32 s63, s61, 1
    s_mul_i32 s57, s60, 86
    s_add_u32 s57, s57, s41
    s_lshl_b32 s57, s57, 10
    s_add_u32 s57, s57, 10485760
    v_add_u32 v40, s57, v50
    s_mul_i32 s57, s61, 86
    s_add_u32 s57, s57, s41
    s_lshl_b32 s57, s57, 10
    v_add_u32 v41, s57, v50
    s_mul_i32 s57, s62, 86
    s_add_u32 s57, s57, s41
    s_lshl_b32 s57, s57, 10
    s_add_u32 s57, s57, 10485760
    v_add_u32 v42, s57, v50
    s_mul_i32 s57, s63, 86
    s_add_u32 s57, s57, s41
    s_lshl_b32 s57, s57, 10
    v_add_u32 v43, s57, v50
    s_mov_b32 s59, 20480
    s_cmp_ge_u32 s24, 2
    s_cselect_b32 s59, 0x10000000, s59
    v_add_u32 v14, s41, v13
    v_lshlrev_b32 v14, 3, v14
    v_add_u32 v14, s39, v14
    v_lshrrev_b32 v15, 2, v14
    v_lshlrev_b32 v15, 7, v15
    v_and_b32 v14, 3, v14
    v_lshlrev_b32 v14, 3, v14
    s_mov_b32 s56, 5963776
    v_add3_u32 v52, v14, v15, s56
    s_cmp_ge_u32 s24, 2
    s_mov_b32 s72, 0x3fffff
    s_cselect_b32 s72, 0x1fffff, s72
    s_mov_b32 s73, 0
    s_lshr_b32 s56, s24, 1
    s_mul_i32 s56, s56, 7
    s_and_b32 s57, s24, 1
    s_mul_i32 s58, s57, 3
    s_add_u32 s56, s56, s58
    s_cmp_eq_u32 s57, 1
    s_mov_b32 s74, 0xff
    s_cselect_b32 s74, 0x3ff, s74
    s_mov_b32 s75, 0
    s_lshl_b32 s57, s38, 4
    s_add_u32 s56, s56, s57
    s_lshl_b32 s56, s56, 7
    s_add_u32 s56, s56, 5832704
    v_and_b32 v14, 1, v13
    v_lshlrev_b32 v14, 11, v14
    v_lshrrev_b32 v15, 1, v13
    v_lshlrev_b32 v15, 7, v15
    v_add3_u32 v51, v14, v15, s56
    s_lshl_b32 s56, s39, 5
    s_lshl_b32 s57, s38, 2
    s_sub_u32 s57, s57, 32
    v_cmp_gt_u32 vcc, 32, v13
    v_mov_b32 v14, s57
    v_mov_b32 v15, s56
    v_cndmask_b32 v14, v14, v15, vcc
    v_add_u32 v14, v14, v13
    v_lshlrev_b32 v14, 7, v14
    v_add_u32 v44, 5799936, v14
    s_mov_b32 s76, -1
    s_mov_b32 s77, 0xff
    s_lshl_b32 s56, s60, 17
    s_lshl_b32 s57, s61, 6
    s_add_u32 s56, s56, s57
    s_add_u32 s56, s56, 12582912
    v_lshrrev_b32 v14, 2, v13
    v_lshlrev_b32 v14, 12, v14
    v_and_b32 v15, 3, v13
    v_lshlrev_b32 v16, 4, v15
    v_add3_u32 v45, v14, v16, s56
    v_and_b32 v17, 31, v13
    s_lshl_b32 s56, s61, 8
    s_add_u32 s56, s56, 5767168
    v_lshlrev_b32 v14, 3, v17
    v_add_u32 v46, s56, v14
    s_mul_i32 s65, s24, 20480
    s_add_u32 s56, s65, 18432
    v_add_u32 v47, s56, v50
    v_lshrrev_b32 v14, 5, v13
    v_lshlrev_b32 v14, 2, v14
    v_bfe_u32 v16, v13, 2, 2
    v_add_u32 v14, v14, v16
    v_lshlrev_b32 v14, 6, v14
    v_bfe_u32 v16, v13, 4, 1
    v_lshlrev_b32 v16, 5, v16
    v_lshlrev_b32 v15, 3, v15
    v_add3_u32 v14, v14, v16, v15
    v_add_u32 v48, s56, v14
    s_lshl_b32 s56, s61, 15
    s_lshl_b32 s57, s60, 6
    s_add_u32 s56, s56, s57
    v_lshlrev_b32 v14, 10, v17
    v_lshrrev_b32 v15, 5, v13
    v_lshlrev_b32 v15, 4, v15
    v_add3_u32 v49, v14, v15, s56
    s_xor_b32 s56, s24, 1
    s_mul_i32 s56, s56, 20480
    s_add_u32 s66, s56, 0
    s_xor_b32 s56, s24, 2
    s_mul_i32 s56, s56, 20480
    s_add_u32 s67, s56, 4096
    s_xor_b32 s56, s24, 3
    s_mul_i32 s56, s56, 20480
    s_add_u32 s68, s56, 8192
    s_mul_i32 s69, s24, 12288
    s_cmp_lg_u32 s29, 0
    s_cbranch_scc1 Pidle_1
    s_waitcnt vmcnt(10)
    s_barrier
    ds_read_b128 v[184:187], v2 offset:0
    ds_read_b128 v[188:191], v3 offset:0
    ds_read_b128 v[192:195], v4 offset:0
    ds_read_b128 v[196:199], v5 offset:0
    ds_read_b64_tr_b16 v[160:161], v1 offset:0
    ds_read_b64_tr_b16 v[162:163], v1 offset:768
    ds_read_b64_tr_b16 v[164:165], v1 offset:6144
    ds_read_b64_tr_b16 v[166:167], v1 offset:6912
    ds_read_b64_tr_b16 v[168:169], v1 offset:64
    ds_read_b64_tr_b16 v[170:171], v1 offset:832
    ds_read_b64_tr_b16 v[172:173], v1 offset:6208
    ds_read_b64_tr_b16 v[174:175], v1 offset:6976
    ds_read_b64_tr_b16 v[176:177], v1 offset:128
    ds_read_b64_tr_b16 v[178:179], v1 offset:896
    ds_read_b64_tr_b16 v[180:181], v1 offset:6272
    ds_read_b64_tr_b16 v[182:183], v1 offset:7040
    s_setprio 2
    s_waitcnt lgkmcnt(10)
    v_mfma_f32_32x32x16_bf16 v[64:79], v[160:163], v[184:187], 0
    ds_read_b64_tr_b16 v[160:161], v1 offset:3072
    ds_read_b64_tr_b16 v[162:163], v1 offset:3840
    s_waitcnt lgkmcnt(10)
    v_mfma_f32_32x32x16_bf16 v[80:95], v[164:167], v[184:187], 0
    ds_read_b64_tr_b16 v[164:165], v1 offset:9216
    ds_read_b64_tr_b16 v[166:167], v1 offset:9984
    s_add_u32 m0, s35, 36864
    s_mov_b32 s27, 264192
    buffer_load_dwordx4 v6, s[16:19], s27 offen offset:0 lds
    s_waitcnt lgkmcnt(10)
    v_mfma_f32_32x32x16_bf16 v[96:111], v[168:171], v[184:187], 0
    ds_read_b64_tr_b16 v[168:169], v1 offset:3136
    ds_read_b64_tr_b16 v[170:171], v1 offset:3904
    s_waitcnt lgkmcnt(10)
    v_mfma_f32_32x32x16_bf16 v[112:127], v[172:175], v[184:187], 0
    ds_read_b64_tr_b16 v[172:173], v1 offset:9280
    ds_read_b64_tr_b16 v[174:175], v1 offset:10048
    buffer_load_dwordx4 v7, s[16:19], s27 offen offset:1024 lds
    s_waitcnt lgkmcnt(10)
    v_mfma_f32_32x32x16_bf16 v[128:143], v[176:179], v[184:187], 0
    ds_read_b64_tr_b16 v[176:177], v1 offset:3200
    ds_read_b64_tr_b16 v[178:179], v1 offset:3968
    s_waitcnt lgkmcnt(10)
    v_mfma_f32_32x32x16_bf16 v[144:159], v[180:183], v[184:187], 0
    ds_read_b64_tr_b16 v[180:181], v1 offset:9344
    ds_read_b64_tr_b16 v[182:183], v1 offset:10112
    buffer_load_dwordx4 v8, s[16:19], s27 offen offset:2048 lds
    s_waitcnt lgkmcnt(10)
    v_mfma_f32_32x32x16_bf16 v[64:79], v[160:163], v[188:191], v[64:79]
    s_waitcnt vmcnt(10)
    s_barrier
    ds_read_b64_tr_b16 v[160:161], v1 offset:12288
    ds_read_b64_tr_b16 v[162:163], v1 offset:13056
    s_waitcnt lgkmcnt(10)
    v_mfma_f32_32x32x16_bf16 v[80:95], v[164:167], v[188:191], v[80:95]
    ds_read_b64_tr_b16 v[164:165], v1 offset:18432
    ds_read_b64_tr_b16 v[166:167], v1 offset:19200
    s_add_u32 m0, s36, 0
    s_mov_b32 s28, 256
    buffer_load_dwordx4 v9, s[12:15], s28 offen offset:0 lds
    s_waitcnt lgkmcnt(10)
    v_mfma_f32_32x32x16_bf16 v[96:111], v[168:171], v[188:191], v[96:111]
    ds_read_b64_tr_b16 v[168:169], v1 offset:12352
    ds_read_b64_tr_b16 v[170:171], v1 offset:13120
    buffer_load_dwordx4 v10, s[12:15], s28 offen offset:1024 lds
    s_waitcnt lgkmcnt(10)
    v_mfma_f32_32x32x16_bf16 v[112:127], v[172:175], v[188:191], v[112:127]
    ds_read_b64_tr_b16 v[172:173], v1 offset:18496
    ds_read_b64_tr_b16 v[174:175], v1 offset:19264
    s_mov_b32 s28, 14592
    s_nop 0
    buffer_load_dwordx4 v9, s[12:15], s28 offen offset:2048 lds
    s_waitcnt lgkmcnt(10)
    v_mfma_f32_32x32x16_bf16 v[128:143], v[176:179], v[188:191], v[128:143]
    ds_read_b64_tr_b16 v[176:177], v1 offset:12416
    ds_read_b64_tr_b16 v[178:179], v1 offset:13184
    buffer_load_dwordx4 v10, s[12:15], s28 offen offset:3072 lds
    s_waitcnt lgkmcnt(10)
    v_mfma_f32_32x32x16_bf16 v[144:159], v[180:183], v[188:191], v[144:159]
    ds_read_b64_tr_b16 v[180:181], v1 offset:18560
    ds_read_b64_tr_b16 v[182:183], v1 offset:19328
    s_waitcnt lgkmcnt(10)
    v_mfma_f32_32x32x16_bf16 v[64:79], v[160:163], v[192:195], v[64:79]
    ds_read_b64_tr_b16 v[160:161], v1 offset:15360
    ds_read_b64_tr_b16 v[162:163], v1 offset:16128
    s_waitcnt vmcnt(10)
    ds_read_b128 v[200:203], v2 offset:16384
    ds_read_b128 v[204:207], v3 offset:16384
    s_waitcnt lgkmcnt(12)
    v_mfma_f32_32x32x16_bf16 v[80:95], v[164:167], v[192:195], v[80:95]
    ds_read_b64_tr_b16 v[164:165], v1 offset:21504
    ds_read_b64_tr_b16 v[166:167], v1 offset:22272
    s_add_u32 m0, s35, 0
    s_mov_b32 s27, 352256
    buffer_load_dwordx4 v6, s[16:19], s27 offen offset:0 lds
    s_waitcnt lgkmcnt(12)
    v_mfma_f32_32x32x16_bf16 v[96:111], v[168:171], v[192:195], v[96:111]
    ds_read_b64_tr_b16 v[168:169], v1 offset:15424
    ds_read_b64_tr_b16 v[170:171], v1 offset:16192
    ds_read_b128 v[208:211], v4 offset:16384
    s_waitcnt lgkmcnt(13)
    v_mfma_f32_32x32x16_bf16 v[112:127], v[172:175], v[192:195], v[112:127]
    ds_read_b64_tr_b16 v[172:173], v1 offset:21568
    ds_read_b64_tr_b16 v[174:175], v1 offset:22336
    buffer_load_dwordx4 v7, s[16:19], s27 offen offset:1024 lds
    s_waitcnt lgkmcnt(13)
    v_mfma_f32_32x32x16_bf16 v[128:143], v[176:179], v[192:195], v[128:143]
    ds_read_b64_tr_b16 v[176:177], v1 offset:15488
    ds_read_b64_tr_b16 v[178:179], v1 offset:16256
    ds_read_b128 v[212:215], v5 offset:16384
    s_waitcnt lgkmcnt(14)
    v_mfma_f32_32x32x16_bf16 v[144:159], v[180:183], v[192:195], v[144:159]
    ds_read_b64_tr_b16 v[180:181], v1 offset:21632
    ds_read_b64_tr_b16 v[182:183], v1 offset:22400
    buffer_load_dwordx4 v8, s[16:19], s27 offen offset:2048 lds
    s_waitcnt lgkmcnt(14)
    v_mfma_f32_32x32x16_bf16 v[64:79], v[160:163], v[196:199], v[64:79]
    s_waitcnt vmcnt(10)
    s_barrier
    ds_read_b64_tr_b16 v[160:161], v1 offset:24576
    ds_read_b64_tr_b16 v[162:163], v1 offset:25344
    s_waitcnt lgkmcnt(12)
    v_mfma_f32_32x32x16_bf16 v[80:95], v[164:167], v[196:199], v[80:95]
    ds_read_b64_tr_b16 v[164:165], v1 offset:30720
    ds_read_b64_tr_b16 v[166:167], v1 offset:31488
    s_waitcnt lgkmcnt(12)
    v_mfma_f32_32x32x16_bf16 v[96:111], v[168:171], v[196:199], v[96:111]
    ds_read_b64_tr_b16 v[168:169], v1 offset:24640
    ds_read_b64_tr_b16 v[170:171], v1 offset:25408
    s_waitcnt lgkmcnt(11)
    v_mfma_f32_32x32x16_bf16 v[112:127], v[172:175], v[196:199], v[112:127]
    ds_read_b64_tr_b16 v[172:173], v1 offset:30784
    ds_read_b64_tr_b16 v[174:175], v1 offset:31552
    s_waitcnt lgkmcnt(11)
    v_mfma_f32_32x32x16_bf16 v[128:143], v[176:179], v[196:199], v[128:143]
    ds_read_b64_tr_b16 v[176:177], v1 offset:24704
    ds_read_b64_tr_b16 v[178:179], v1 offset:25472
    s_waitcnt lgkmcnt(10)
    v_mfma_f32_32x32x16_bf16 v[144:159], v[180:183], v[196:199], v[144:159]
    ds_read_b64_tr_b16 v[180:181], v1 offset:30848
    ds_read_b64_tr_b16 v[182:183], v1 offset:31616
    s_waitcnt lgkmcnt(10)
    v_mfma_f32_32x32x16_bf16 v[64:79], v[160:163], v[200:203], v[64:79]
    ds_read_b64_tr_b16 v[160:161], v1 offset:27648
    ds_read_b64_tr_b16 v[162:163], v1 offset:28416
    s_waitcnt lgkmcnt(10)
    v_mfma_f32_32x32x16_bf16 v[80:95], v[164:167], v[200:203], v[80:95]
    ds_read_b64_tr_b16 v[164:165], v1 offset:33792
    ds_read_b64_tr_b16 v[166:167], v1 offset:34560
    s_add_u32 m0, s35, 12288
    s_mov_b32 s27, 440320
    buffer_load_dwordx4 v6, s[16:19], s27 offen offset:0 lds
    s_waitcnt lgkmcnt(10)
    v_mfma_f32_32x32x16_bf16 v[96:111], v[168:171], v[200:203], v[96:111]
    ds_read_b64_tr_b16 v[168:169], v1 offset:27712
    ds_read_b64_tr_b16 v[170:171], v1 offset:28480
    s_waitcnt lgkmcnt(10)
    v_mfma_f32_32x32x16_bf16 v[112:127], v[172:175], v[200:203], v[112:127]
    ds_read_b64_tr_b16 v[172:173], v1 offset:33856
    ds_read_b64_tr_b16 v[174:175], v1 offset:34624
    buffer_load_dwordx4 v7, s[16:19], s27 offen offset:1024 lds
    s_waitcnt lgkmcnt(10)
    v_mfma_f32_32x32x16_bf16 v[128:143], v[176:179], v[200:203], v[128:143]
    ds_read_b64_tr_b16 v[176:177], v1 offset:27776
    ds_read_b64_tr_b16 v[178:179], v1 offset:28544
    s_waitcnt lgkmcnt(10)
    v_mfma_f32_32x32x16_bf16 v[144:159], v[180:183], v[200:203], v[144:159]
    ds_read_b64_tr_b16 v[180:181], v1 offset:33920
    ds_read_b64_tr_b16 v[182:183], v1 offset:34688
    buffer_load_dwordx4 v8, s[16:19], s27 offen offset:2048 lds
    s_waitcnt lgkmcnt(10)
    v_mfma_f32_32x32x16_bf16 v[64:79], v[160:163], v[204:207], v[64:79]
    s_waitcnt vmcnt(10)
    s_barrier
    ds_read_b64_tr_b16 v[160:161], v1 offset:36864
    ds_read_b64_tr_b16 v[162:163], v1 offset:37632
    s_waitcnt lgkmcnt(10)
    v_mfma_f32_32x32x16_bf16 v[80:95], v[164:167], v[204:207], v[80:95]
    ds_read_b64_tr_b16 v[164:165], v1 offset:43008
    ds_read_b64_tr_b16 v[166:167], v1 offset:43776
    s_add_u32 m0, s36, 16384
    s_mov_b32 s28, 384
    buffer_load_dwordx4 v9, s[12:15], s28 offen offset:0 lds
    s_waitcnt lgkmcnt(10)
    v_mfma_f32_32x32x16_bf16 v[96:111], v[168:171], v[204:207], v[96:111]
    ds_read_b64_tr_b16 v[168:169], v1 offset:36928
    ds_read_b64_tr_b16 v[170:171], v1 offset:37696
    buffer_load_dwordx4 v10, s[12:15], s28 offen offset:1024 lds
    s_waitcnt lgkmcnt(10)
    v_mfma_f32_32x32x16_bf16 v[112:127], v[172:175], v[204:207], v[112:127]
    ds_read_b64_tr_b16 v[172:173], v1 offset:43072
    ds_read_b64_tr_b16 v[174:175], v1 offset:43840
    s_mov_b32 s28, 14720
    s_nop 0
    buffer_load_dwordx4 v9, s[12:15], s28 offen offset:2048 lds
    s_waitcnt lgkmcnt(10)
    v_mfma_f32_32x32x16_bf16 v[128:143], v[176:179], v[204:207], v[128:143]
    ds_read_b64_tr_b16 v[176:177], v1 offset:36992
    ds_read_b64_tr_b16 v[178:179], v1 offset:37760
    buffer_load_dwordx4 v10, s[12:15], s28 offen offset:3072 lds
    s_waitcnt lgkmcnt(10)
    v_mfma_f32_32x32x16_bf16 v[144:159], v[180:183], v[204:207], v[144:159]
    ds_read_b64_tr_b16 v[180:181], v1 offset:43136
    ds_read_b64_tr_b16 v[182:183], v1 offset:43904
    s_waitcnt lgkmcnt(10)
    v_mfma_f32_32x32x16_bf16 v[64:79], v[160:163], v[208:211], v[64:79]
    ds_read_b64_tr_b16 v[160:161], v1 offset:39936
    ds_read_b64_tr_b16 v[162:163], v1 offset:40704
    s_waitcnt vmcnt(10)
    ds_read_b128 v[184:187], v2 offset:0
    ds_read_b128 v[188:191], v3 offset:0
    s_waitcnt lgkmcnt(12)
    v_mfma_f32_32x32x16_bf16 v[80:95], v[164:167], v[208:211], v[80:95]
    ds_read_b64_tr_b16 v[164:165], v1 offset:46080
    ds_read_b64_tr_b16 v[166:167], v1 offset:46848
    s_add_u32 m0, s35, 24576
    s_mov_b32 s27, 528384
    buffer_load_dwordx4 v6, s[16:19], s27 offen offset:0 lds
    s_waitcnt lgkmcnt(12)
    v_mfma_f32_32x32x16_bf16 v[96:111], v[168:171], v[208:211], v[96:111]
    ds_read_b64_tr_b16 v[168:169], v1 offset:40000
    ds_read_b64_tr_b16 v[170:171], v1 offset:40768
    ds_read_b128 v[192:195], v4 offset:0
    s_waitcnt lgkmcnt(13)
    v_mfma_f32_32x32x16_bf16 v[112:127], v[172:175], v[208:211], v[112:127]
    ds_read_b64_tr_b16 v[172:173], v1 offset:46144
    ds_read_b64_tr_b16 v[174:175], v1 offset:46912
    buffer_load_dwordx4 v7, s[16:19], s27 offen offset:1024 lds
    s_waitcnt lgkmcnt(13)
    v_mfma_f32_32x32x16_bf16 v[128:143], v[176:179], v[208:211], v[128:143]
    ds_read_b64_tr_b16 v[176:177], v1 offset:40064
    ds_read_b64_tr_b16 v[178:179], v1 offset:40832
    ds_read_b128 v[196:199], v5 offset:0
    s_waitcnt lgkmcnt(14)
    v_mfma_f32_32x32x16_bf16 v[144:159], v[180:183], v[208:211], v[144:159]
    ds_read_b64_tr_b16 v[180:181], v1 offset:46208
    ds_read_b64_tr_b16 v[182:183], v1 offset:46976
    buffer_load_dwordx4 v8, s[16:19], s27 offen offset:2048 lds
    s_waitcnt lgkmcnt(14)
    v_mfma_f32_32x32x16_bf16 v[64:79], v[160:163], v[212:215], v[64:79]
    s_waitcnt vmcnt(10)
    s_barrier
    ds_read_b64_tr_b16 v[160:161], v1 offset:0
    ds_read_b64_tr_b16 v[162:163], v1 offset:768
    s_waitcnt lgkmcnt(12)
    v_mfma_f32_32x32x16_bf16 v[80:95], v[164:167], v[212:215], v[80:95]
    ds_read_b64_tr_b16 v[164:165], v1 offset:6144
    ds_read_b64_tr_b16 v[166:167], v1 offset:6912
    s_waitcnt lgkmcnt(12)
    v_mfma_f32_32x32x16_bf16 v[96:111], v[168:171], v[212:215], v[96:111]
    ds_read_b64_tr_b16 v[168:169], v1 offset:64
    ds_read_b64_tr_b16 v[170:171], v1 offset:832
    s_waitcnt lgkmcnt(11)
    v_mfma_f32_32x32x16_bf16 v[112:127], v[172:175], v[212:215], v[112:127]
    ds_read_b64_tr_b16 v[172:173], v1 offset:6208
    ds_read_b64_tr_b16 v[174:175], v1 offset:6976
    s_waitcnt lgkmcnt(11)
    v_mfma_f32_32x32x16_bf16 v[128:143], v[176:179], v[212:215], v[128:143]
    ds_read_b64_tr_b16 v[176:177], v1 offset:128
    ds_read_b64_tr_b16 v[178:179], v1 offset:896
    s_waitcnt lgkmcnt(10)
    v_mfma_f32_32x32x16_bf16 v[144:159], v[180:183], v[212:215], v[144:159]
    ds_read_b64_tr_b16 v[180:181], v1 offset:6272
    ds_read_b64_tr_b16 v[182:183], v1 offset:7040
    s_waitcnt lgkmcnt(10)
    v_mfma_f32_32x32x16_bf16 v[64:79], v[160:163], v[184:187], v[64:79]
    ds_read_b64_tr_b16 v[160:161], v1 offset:3072
    ds_read_b64_tr_b16 v[162:163], v1 offset:3840
    s_waitcnt lgkmcnt(10)
    v_mfma_f32_32x32x16_bf16 v[80:95], v[164:167], v[184:187], v[80:95]
    ds_read_b64_tr_b16 v[164:165], v1 offset:9216
    ds_read_b64_tr_b16 v[166:167], v1 offset:9984
    s_add_u32 m0, s35, 36864
    s_mov_b32 s27, 616448
    buffer_load_dwordx4 v6, s[16:19], s27 offen offset:0 lds
    s_waitcnt lgkmcnt(10)
    v_mfma_f32_32x32x16_bf16 v[96:111], v[168:171], v[184:187], v[96:111]
    ds_read_b64_tr_b16 v[168:169], v1 offset:3136
    ds_read_b64_tr_b16 v[170:171], v1 offset:3904
    s_waitcnt lgkmcnt(10)
    v_mfma_f32_32x32x16_bf16 v[112:127], v[172:175], v[184:187], v[112:127]
    ds_read_b64_tr_b16 v[172:173], v1 offset:9280
    ds_read_b64_tr_b16 v[174:175], v1 offset:10048
    buffer_load_dwordx4 v7, s[16:19], s27 offen offset:1024 lds
    s_waitcnt lgkmcnt(10)
    v_mfma_f32_32x32x16_bf16 v[128:143], v[176:179], v[184:187], v[128:143]
    ds_read_b64_tr_b16 v[176:177], v1 offset:3200
    ds_read_b64_tr_b16 v[178:179], v1 offset:3968
    s_waitcnt lgkmcnt(10)
    v_mfma_f32_32x32x16_bf16 v[144:159], v[180:183], v[184:187], v[144:159]
    ds_read_b64_tr_b16 v[180:181], v1 offset:9344
    ds_read_b64_tr_b16 v[182:183], v1 offset:10112
    buffer_load_dwordx4 v8, s[16:19], s27 offen offset:2048 lds
    s_waitcnt lgkmcnt(10)
    v_mfma_f32_32x32x16_bf16 v[64:79], v[160:163], v[188:191], v[64:79]
    s_waitcnt vmcnt(10)
    s_barrier
    ds_read_b64_tr_b16 v[160:161], v1 offset:12288
    ds_read_b64_tr_b16 v[162:163], v1 offset:13056
    s_waitcnt lgkmcnt(10)
    v_mfma_f32_32x32x16_bf16 v[80:95], v[164:167], v[188:191], v[80:95]
    ds_read_b64_tr_b16 v[164:165], v1 offset:18432
    ds_read_b64_tr_b16 v[166:167], v1 offset:19200
    s_add_u32 m0, s36, 0
    s_mov_b32 s28, 512
    buffer_load_dwordx4 v9, s[12:15], s28 offen offset:0 lds
    s_waitcnt lgkmcnt(10)
    v_mfma_f32_32x32x16_bf16 v[96:111], v[168:171], v[188:191], v[96:111]
    ds_read_b64_tr_b16 v[168:169], v1 offset:12352
    ds_read_b64_tr_b16 v[170:171], v1 offset:13120
    buffer_load_dwordx4 v10, s[12:15], s28 offen offset:1024 lds
    s_waitcnt lgkmcnt(10)
    v_mfma_f32_32x32x16_bf16 v[112:127], v[172:175], v[188:191], v[112:127]
    ds_read_b64_tr_b16 v[172:173], v1 offset:18496
    ds_read_b64_tr_b16 v[174:175], v1 offset:19264
    s_mov_b32 s28, 14848
    s_nop 0
    buffer_load_dwordx4 v9, s[12:15], s28 offen offset:2048 lds
    s_waitcnt lgkmcnt(10)
    v_mfma_f32_32x32x16_bf16 v[128:143], v[176:179], v[188:191], v[128:143]
    ds_read_b64_tr_b16 v[176:177], v1 offset:12416
    ds_read_b64_tr_b16 v[178:179], v1 offset:13184
    buffer_load_dwordx4 v10, s[12:15], s28 offen offset:3072 lds
    s_waitcnt lgkmcnt(10)
    v_mfma_f32_32x32x16_bf16 v[144:159], v[180:183], v[188:191], v[144:159]
    ds_read_b64_tr_b16 v[180:181], v1 offset:18560
    ds_read_b64_tr_b16 v[182:183], v1 offset:19328
    s_waitcnt lgkmcnt(10)
    v_mfma_f32_32x32x16_bf16 v[64:79], v[160:163], v[192:195], v[64:79]
    ds_read_b64_tr_b16 v[160:161], v1 offset:15360
    ds_read_b64_tr_b16 v[162:163], v1 offset:16128
    s_waitcnt vmcnt(10)
    ds_read_b128 v[200:203], v2 offset:16384
    ds_read_b128 v[204:207], v3 offset:16384
    s_waitcnt lgkmcnt(12)
    v_mfma_f32_32x32x16_bf16 v[80:95], v[164:167], v[192:195], v[80:95]
    ds_read_b64_tr_b16 v[164:165], v1 offset:21504
    ds_read_b64_tr_b16 v[166:167], v1 offset:22272
    s_add_u32 m0, s35, 0
    s_mov_b32 s27, 704512
    buffer_load_dwordx4 v6, s[16:19], s27 offen offset:0 lds
    s_waitcnt lgkmcnt(12)
    v_mfma_f32_32x32x16_bf16 v[96:111], v[168:171], v[192:195], v[96:111]
    ds_read_b64_tr_b16 v[168:169], v1 offset:15424
    ds_read_b64_tr_b16 v[170:171], v1 offset:16192
    ds_read_b128 v[208:211], v4 offset:16384
    s_waitcnt lgkmcnt(13)
    v_mfma_f32_32x32x16_bf16 v[112:127], v[172:175], v[192:195], v[112:127]
    ds_read_b64_tr_b16 v[172:173], v1 offset:21568
    ds_read_b64_tr_b16 v[174:175], v1 offset:22336
    buffer_load_dwordx4 v7, s[16:19], s27 offen offset:1024 lds
    s_waitcnt lgkmcnt(13)
    v_mfma_f32_32x32x16_bf16 v[128:143], v[176:179], v[192:195], v[128:143]
    ds_read_b64_tr_b16 v[176:177], v1 offset:15488
    ds_read_b64_tr_b16 v[178:179], v1 offset:16256
    ds_read_b128 v[212:215], v5 offset:16384
    s_waitcnt lgkmcnt(14)
    v_mfma_f32_32x32x16_bf16 v[144:159], v[180:183], v[192:195], v[144:159]
    ds_read_b64_tr_b16 v[180:181], v1 offset:21632
    ds_read_b64_tr_b16 v[182:183], v1 offset:22400
    buffer_load_dwordx4 v8, s[16:19], s27 offen offset:2048 lds
    s_waitcnt lgkmcnt(14)
    v_mfma_f32_32x32x16_bf16 v[64:79], v[160:163], v[196:199], v[64:79]
    s_waitcnt vmcnt(10)
    s_barrier
    ds_read_b64_tr_b16 v[160:161], v1 offset:24576
    ds_read_b64_tr_b16 v[162:163], v1 offset:25344
    s_waitcnt lgkmcnt(12)
    v_mfma_f32_32x32x16_bf16 v[80:95], v[164:167], v[196:199], v[80:95]
    ds_read_b64_tr_b16 v[164:165], v1 offset:30720
    ds_read_b64_tr_b16 v[166:167], v1 offset:31488
    s_waitcnt lgkmcnt(12)
    v_mfma_f32_32x32x16_bf16 v[96:111], v[168:171], v[196:199], v[96:111]
    ds_read_b64_tr_b16 v[168:169], v1 offset:24640
    ds_read_b64_tr_b16 v[170:171], v1 offset:25408
    s_waitcnt lgkmcnt(11)
    v_mfma_f32_32x32x16_bf16 v[112:127], v[172:175], v[196:199], v[112:127]
    ds_read_b64_tr_b16 v[172:173], v1 offset:30784
    ds_read_b64_tr_b16 v[174:175], v1 offset:31552
    s_waitcnt lgkmcnt(11)
    v_mfma_f32_32x32x16_bf16 v[128:143], v[176:179], v[196:199], v[128:143]
    ds_read_b64_tr_b16 v[176:177], v1 offset:24704
    ds_read_b64_tr_b16 v[178:179], v1 offset:25472
    s_waitcnt lgkmcnt(10)
    v_mfma_f32_32x32x16_bf16 v[144:159], v[180:183], v[196:199], v[144:159]
    ds_read_b64_tr_b16 v[180:181], v1 offset:30848
    ds_read_b64_tr_b16 v[182:183], v1 offset:31616
    s_waitcnt lgkmcnt(10)
    v_mfma_f32_32x32x16_bf16 v[64:79], v[160:163], v[200:203], v[64:79]
    ds_read_b64_tr_b16 v[160:161], v1 offset:27648
    ds_read_b64_tr_b16 v[162:163], v1 offset:28416
    s_waitcnt lgkmcnt(10)
    v_mfma_f32_32x32x16_bf16 v[80:95], v[164:167], v[200:203], v[80:95]
    ds_read_b64_tr_b16 v[164:165], v1 offset:33792
    ds_read_b64_tr_b16 v[166:167], v1 offset:34560
    s_add_u32 m0, s35, 12288
    s_mov_b32 s27, 792576
    buffer_load_dwordx4 v6, s[16:19], s27 offen offset:0 lds
    s_waitcnt lgkmcnt(10)
    v_mfma_f32_32x32x16_bf16 v[96:111], v[168:171], v[200:203], v[96:111]
    ds_read_b64_tr_b16 v[168:169], v1 offset:27712
    ds_read_b64_tr_b16 v[170:171], v1 offset:28480
    s_waitcnt lgkmcnt(10)
    v_mfma_f32_32x32x16_bf16 v[112:127], v[172:175], v[200:203], v[112:127]
    ds_read_b64_tr_b16 v[172:173], v1 offset:33856
    ds_read_b64_tr_b16 v[174:175], v1 offset:34624
    buffer_load_dwordx4 v7, s[16:19], s27 offen offset:1024 lds
    s_waitcnt lgkmcnt(10)
    v_mfma_f32_32x32x16_bf16 v[128:143], v[176:179], v[200:203], v[128:143]
    ds_read_b64_tr_b16 v[176:177], v1 offset:27776
    ds_read_b64_tr_b16 v[178:179], v1 offset:28544
    s_waitcnt lgkmcnt(10)
    v_mfma_f32_32x32x16_bf16 v[144:159], v[180:183], v[200:203], v[144:159]
    ds_read_b64_tr_b16 v[180:181], v1 offset:33920
    ds_read_b64_tr_b16 v[182:183], v1 offset:34688
    buffer_load_dwordx4 v8, s[16:19], s27 offen offset:2048 lds
    s_waitcnt lgkmcnt(10)
    v_mfma_f32_32x32x16_bf16 v[64:79], v[160:163], v[204:207], v[64:79]
    s_waitcnt vmcnt(10)
    s_barrier
    ds_read_b64_tr_b16 v[160:161], v1 offset:36864
    ds_read_b64_tr_b16 v[162:163], v1 offset:37632
    s_waitcnt lgkmcnt(10)
    v_mfma_f32_32x32x16_bf16 v[80:95], v[164:167], v[204:207], v[80:95]
    ds_read_b64_tr_b16 v[164:165], v1 offset:43008
    ds_read_b64_tr_b16 v[166:167], v1 offset:43776
    s_add_u32 m0, s36, 16384
    s_mov_b32 s28, 640
    buffer_load_dwordx4 v9, s[12:15], s28 offen offset:0 lds
    s_waitcnt lgkmcnt(10)
    v_mfma_f32_32x32x16_bf16 v[96:111], v[168:171], v[204:207], v[96:111]
    ds_read_b64_tr_b16 v[168:169], v1 offset:36928
    ds_read_b64_tr_b16 v[170:171], v1 offset:37696
    buffer_load_dwordx4 v10, s[12:15], s28 offen offset:1024 lds
    s_waitcnt lgkmcnt(10)
    v_mfma_f32_32x32x16_bf16 v[112:127], v[172:175], v[204:207], v[112:127]
    ds_read_b64_tr_b16 v[172:173], v1 offset:43072
    ds_read_b64_tr_b16 v[174:175], v1 offset:43840
    s_mov_b32 s28, 14976
    s_nop 0
    buffer_load_dwordx4 v9, s[12:15], s28 offen offset:2048 lds
    s_waitcnt lgkmcnt(10)
    v_mfma_f32_32x32x16_bf16 v[128:143], v[176:179], v[204:207], v[128:143]
    ds_read_b64_tr_b16 v[176:177], v1 offset:36992
    ds_read_b64_tr_b16 v[178:179], v1 offset:37760
    buffer_load_dwordx4 v10, s[12:15], s28 offen offset:3072 lds
    s_waitcnt lgkmcnt(10)
    v_mfma_f32_32x32x16_bf16 v[144:159], v[180:183], v[204:207], v[144:159]
    ds_read_b64_tr_b16 v[180:181], v1 offset:43136
    ds_read_b64_tr_b16 v[182:183], v1 offset:43904
    s_waitcnt lgkmcnt(10)
    v_mfma_f32_32x32x16_bf16 v[64:79], v[160:163], v[208:211], v[64:79]
    ds_read_b64_tr_b16 v[160:161], v1 offset:39936
    ds_read_b64_tr_b16 v[162:163], v1 offset:40704
    s_waitcnt vmcnt(10)
    ds_read_b128 v[184:187], v2 offset:0
    ds_read_b128 v[188:191], v3 offset:0
    s_waitcnt lgkmcnt(12)
    v_mfma_f32_32x32x16_bf16 v[80:95], v[164:167], v[208:211], v[80:95]
    ds_read_b64_tr_b16 v[164:165], v1 offset:46080
    ds_read_b64_tr_b16 v[166:167], v1 offset:46848
    s_add_u32 m0, s35, 24576
    s_mov_b32 s27, 880640
    buffer_load_dwordx4 v6, s[16:19], s27 offen offset:0 lds
    s_waitcnt lgkmcnt(12)
    v_mfma_f32_32x32x16_bf16 v[96:111], v[168:171], v[208:211], v[96:111]
    ds_read_b64_tr_b16 v[168:169], v1 offset:40000
    ds_read_b64_tr_b16 v[170:171], v1 offset:40768
    ds_read_b128 v[192:195], v4 offset:0
    s_waitcnt lgkmcnt(13)
    v_mfma_f32_32x32x16_bf16 v[112:127], v[172:175], v[208:211], v[112:127]
    ds_read_b64_tr_b16 v[172:173], v1 offset:46144
    ds_read_b64_tr_b16 v[174:175], v1 offset:46912
    buffer_load_dwordx4 v7, s[16:19], s27 offen offset:1024 lds
    s_waitcnt lgkmcnt(13)
    v_mfma_f32_32x32x16_bf16 v[128:143], v[176:179], v[208:211], v[128:143]
    ds_read_b64_tr_b16 v[176:177], v1 offset:40064
    ds_read_b64_tr_b16 v[178:179], v1 offset:40832
    ds_read_b128 v[196:199], v5 offset:0
    s_waitcnt lgkmcnt(14)
    v_mfma_f32_32x32x16_bf16 v[144:159], v[180:183], v[208:211], v[144:159]
    ds_read_b64_tr_b16 v[180:181], v1 offset:46208
    ds_read_b64_tr_b16 v[182:183], v1 offset:46976
    buffer_load_dwordx4 v8, s[16:19], s27 offen offset:2048 lds
    s_waitcnt lgkmcnt(14)
    v_mfma_f32_32x32x16_bf16 v[64:79], v[160:163], v[212:215], v[64:79]
    s_waitcnt vmcnt(10)
    s_barrier
    ds_read_b64_tr_b16 v[160:161], v1 offset:0
    ds_read_b64_tr_b16 v[162:163], v1 offset:768
    s_waitcnt lgkmcnt(12)
    v_mfma_f32_32x32x16_bf16 v[80:95], v[164:167], v[212:215], v[80:95]
    ds_read_b64_tr_b16 v[164:165], v1 offset:6144
    ds_read_b64_tr_b16 v[166:167], v1 offset:6912
    s_waitcnt lgkmcnt(12)
    v_mfma_f32_32x32x16_bf16 v[96:111], v[168:171], v[212:215], v[96:111]
    ds_read_b64_tr_b16 v[168:169], v1 offset:64
    ds_read_b64_tr_b16 v[170:171], v1 offset:832
    s_waitcnt lgkmcnt(11)
    v_mfma_f32_32x32x16_bf16 v[112:127], v[172:175], v[212:215], v[112:127]
    ds_read_b64_tr_b16 v[172:173], v1 offset:6208
    ds_read_b64_tr_b16 v[174:175], v1 offset:6976
    s_waitcnt lgkmcnt(11)
    v_mfma_f32_32x32x16_bf16 v[128:143], v[176:179], v[212:215], v[128:143]
    ds_read_b64_tr_b16 v[176:177], v1 offset:128
    ds_read_b64_tr_b16 v[178:179], v1 offset:896
    s_waitcnt lgkmcnt(10)
    v_mfma_f32_32x32x16_bf16 v[144:159], v[180:183], v[212:215], v[144:159]
    ds_read_b64_tr_b16 v[180:181], v1 offset:6272
    ds_read_b64_tr_b16 v[182:183], v1 offset:7040
    s_waitcnt lgkmcnt(10)
    v_mfma_f32_32x32x16_bf16 v[64:79], v[160:163], v[184:187], v[64:79]
    ds_read_b64_tr_b16 v[160:161], v1 offset:3072
    ds_read_b64_tr_b16 v[162:163], v1 offset:3840
    s_waitcnt lgkmcnt(10)
    v_mfma_f32_32x32x16_bf16 v[80:95], v[164:167], v[184:187], v[80:95]
    ds_read_b64_tr_b16 v[164:165], v1 offset:9216
    ds_read_b64_tr_b16 v[166:167], v1 offset:9984
    s_add_u32 m0, s35, 36864
    s_mov_b32 s27, 968704
    buffer_load_dwordx4 v6, s[16:19], s27 offen offset:0 lds
    s_waitcnt lgkmcnt(10)
    v_mfma_f32_32x32x16_bf16 v[96:111], v[168:171], v[184:187], v[96:111]
    ds_read_b64_tr_b16 v[168:169], v1 offset:3136
    ds_read_b64_tr_b16 v[170:171], v1 offset:3904
    s_waitcnt lgkmcnt(10)
    v_mfma_f32_32x32x16_bf16 v[112:127], v[172:175], v[184:187], v[112:127]
    ds_read_b64_tr_b16 v[172:173], v1 offset:9280
    ds_read_b64_tr_b16 v[174:175], v1 offset:10048
    buffer_load_dwordx4 v7, s[16:19], s27 offen offset:1024 lds
    s_waitcnt lgkmcnt(10)
    v_mfma_f32_32x32x16_bf16 v[128:143], v[176:179], v[184:187], v[128:143]
    ds_read_b64_tr_b16 v[176:177], v1 offset:3200
    ds_read_b64_tr_b16 v[178:179], v1 offset:3968
    s_waitcnt lgkmcnt(10)
    v_mfma_f32_32x32x16_bf16 v[144:159], v[180:183], v[184:187], v[144:159]
    ds_read_b64_tr_b16 v[180:181], v1 offset:9344
    ds_read_b64_tr_b16 v[182:183], v1 offset:10112
    buffer_load_dwordx4 v8, s[16:19], s27 offen offset:2048 lds
    s_waitcnt lgkmcnt(10)
    v_mfma_f32_32x32x16_bf16 v[64:79], v[160:163], v[188:191], v[64:79]
    s_waitcnt vmcnt(10)
    s_barrier
    ds_read_b64_tr_b16 v[160:161], v1 offset:12288
    ds_read_b64_tr_b16 v[162:163], v1 offset:13056
    s_waitcnt lgkmcnt(10)
    v_mfma_f32_32x32x16_bf16 v[80:95], v[164:167], v[188:191], v[80:95]
    ds_read_b64_tr_b16 v[164:165], v1 offset:18432
    ds_read_b64_tr_b16 v[166:167], v1 offset:19200
    s_add_u32 m0, s36, 0
    s_mov_b32 s28, 768
    buffer_load_dwordx4 v9, s[12:15], s28 offen offset:0 lds
    s_waitcnt lgkmcnt(10)
    v_mfma_f32_32x32x16_bf16 v[96:111], v[168:171], v[188:191], v[96:111]
    ds_read_b64_tr_b16 v[168:169], v1 offset:12352
    ds_read_b64_tr_b16 v[170:171], v1 offset:13120
    buffer_load_dwordx4 v10, s[12:15], s28 offen offset:1024 lds
    s_waitcnt lgkmcnt(10)
    v_mfma_f32_32x32x16_bf16 v[112:127], v[172:175], v[188:191], v[112:127]
    ds_read_b64_tr_b16 v[172:173], v1 offset:18496
    ds_read_b64_tr_b16 v[174:175], v1 offset:19264
    s_mov_b32 s28, 15104
    s_nop 0
    buffer_load_dwordx4 v9, s[12:15], s28 offen offset:2048 lds
    s_waitcnt lgkmcnt(10)
    v_mfma_f32_32x32x16_bf16 v[128:143], v[176:179], v[188:191], v[128:143]
    ds_read_b64_tr_b16 v[176:177], v1 offset:12416
    ds_read_b64_tr_b16 v[178:179], v1 offset:13184
    buffer_load_dwordx4 v10, s[12:15], s28 offen offset:3072 lds
    s_waitcnt lgkmcnt(10)
    v_mfma_f32_32x32x16_bf16 v[144:159], v[180:183], v[188:191], v[144:159]
    ds_read_b64_tr_b16 v[180:181], v1 offset:18560
    ds_read_b64_tr_b16 v[182:183], v1 offset:19328
    s_waitcnt lgkmcnt(10)
    v_mfma_f32_32x32x16_bf16 v[64:79], v[160:163], v[192:195], v[64:79]
    ds_read_b64_tr_b16 v[160:161], v1 offset:15360
    ds_read_b64_tr_b16 v[162:163], v1 offset:16128
    s_waitcnt vmcnt(10)
    ds_read_b128 v[200:203], v2 offset:16384
    ds_read_b128 v[204:207], v3 offset:16384
    s_waitcnt lgkmcnt(12)
    v_mfma_f32_32x32x16_bf16 v[80:95], v[164:167], v[192:195], v[80:95]
    ds_read_b64_tr_b16 v[164:165], v1 offset:21504
    ds_read_b64_tr_b16 v[166:167], v1 offset:22272
    s_add_u32 m0, s35, 0
    s_mov_b32 s27, 1056768
    buffer_load_dwordx4 v6, s[16:19], s27 offen offset:0 lds
    s_waitcnt lgkmcnt(12)
    v_mfma_f32_32x32x16_bf16 v[96:111], v[168:171], v[192:195], v[96:111]
    ds_read_b64_tr_b16 v[168:169], v1 offset:15424
    ds_read_b64_tr_b16 v[170:171], v1 offset:16192
    ds_read_b128 v[208:211], v4 offset:16384
    s_waitcnt lgkmcnt(13)
    v_mfma_f32_32x32x16_bf16 v[112:127], v[172:175], v[192:195], v[112:127]
    ds_read_b64_tr_b16 v[172:173], v1 offset:21568
    ds_read_b64_tr_b16 v[174:175], v1 offset:22336
    buffer_load_dwordx4 v7, s[16:19], s27 offen offset:1024 lds
    s_waitcnt lgkmcnt(13)
    v_mfma_f32_32x32x16_bf16 v[128:143], v[176:179], v[192:195], v[128:143]
    ds_read_b64_tr_b16 v[176:177], v1 offset:15488
    ds_read_b64_tr_b16 v[178:179], v1 offset:16256
    ds_read_b128 v[212:215], v5 offset:16384
    s_waitcnt lgkmcnt(14)
    v_mfma_f32_32x32x16_bf16 v[144:159], v[180:183], v[192:195], v[144:159]
    ds_read_b64_tr_b16 v[180:181], v1 offset:21632
    ds_read_b64_tr_b16 v[182:183], v1 offset:22400
    buffer_load_dwordx4 v8, s[16:19], s27 offen offset:2048 lds
    s_waitcnt lgkmcnt(14)
    v_mfma_f32_32x32x16_bf16 v[64:79], v[160:163], v[196:199], v[64:79]
    s_waitcnt vmcnt(10)
    s_barrier
    ds_read_b64_tr_b16 v[160:161], v1 offset:24576
    ds_read_b64_tr_b16 v[162:163], v1 offset:25344
    s_waitcnt lgkmcnt(12)
    v_mfma_f32_32x32x16_bf16 v[80:95], v[164:167], v[196:199], v[80:95]
    ds_read_b64_tr_b16 v[164:165], v1 offset:30720
    ds_read_b64_tr_b16 v[166:167], v1 offset:31488
    s_waitcnt lgkmcnt(12)
    v_mfma_f32_32x32x16_bf16 v[96:111], v[168:171], v[196:199], v[96:111]
    ds_read_b64_tr_b16 v[168:169], v1 offset:24640
    ds_read_b64_tr_b16 v[170:171], v1 offset:25408
    s_waitcnt lgkmcnt(11)
    v_mfma_f32_32x32x16_bf16 v[112:127], v[172:175], v[196:199], v[112:127]
    ds_read_b64_tr_b16 v[172:173], v1 offset:30784
    ds_read_b64_tr_b16 v[174:175], v1 offset:31552
    s_waitcnt lgkmcnt(11)
    v_mfma_f32_32x32x16_bf16 v[128:143], v[176:179], v[196:199], v[128:143]
    ds_read_b64_tr_b16 v[176:177], v1 offset:24704
    ds_read_b64_tr_b16 v[178:179], v1 offset:25472
    s_waitcnt lgkmcnt(10)
    v_mfma_f32_32x32x16_bf16 v[144:159], v[180:183], v[196:199], v[144:159]
    ds_read_b64_tr_b16 v[180:181], v1 offset:30848
    ds_read_b64_tr_b16 v[182:183], v1 offset:31616
    global_load_dwordx2 v[54:55], v59, s[46:47] sc1
    s_waitcnt lgkmcnt(10)
    v_mfma_f32_32x32x16_bf16 v[64:79], v[160:163], v[200:203], v[64:79]
    ds_read_b64_tr_b16 v[160:161], v1 offset:27648
    ds_read_b64_tr_b16 v[162:163], v1 offset:28416
    s_waitcnt lgkmcnt(10)
    v_mfma_f32_32x32x16_bf16 v[80:95], v[164:167], v[200:203], v[80:95]
    ds_read_b64_tr_b16 v[164:165], v1 offset:33792
    ds_read_b64_tr_b16 v[166:167], v1 offset:34560
    s_add_u32 m0, s35, 12288
    s_mov_b32 s27, 1144832
    buffer_load_dwordx4 v6, s[16:19], s27 offen offset:0 lds
    s_waitcnt lgkmcnt(10)
    v_mfma_f32_32x32x16_bf16 v[96:111], v[168:171], v[200:203], v[96:111]
    ds_read_b64_tr_b16 v[168:169], v1 offset:27712
    ds_read_b64_tr_b16 v[170:171], v1 offset:28480
    s_waitcnt lgkmcnt(10)
    v_mfma_f32_32x32x16_bf16 v[112:127], v[172:175], v[200:203], v[112:127]
    ds_read_b64_tr_b16 v[172:173], v1 offset:33856
    ds_read_b64_tr_b16 v[174:175], v1 offset:34624
    buffer_load_dwordx4 v7, s[16:19], s27 offen offset:1024 lds
    s_waitcnt lgkmcnt(10)
    v_mfma_f32_32x32x16_bf16 v[128:143], v[176:179], v[200:203], v[128:143]
    ds_read_b64_tr_b16 v[176:177], v1 offset:27776
    ds_read_b64_tr_b16 v[178:179], v1 offset:28544
    s_waitcnt lgkmcnt(10)
    v_mfma_f32_32x32x16_bf16 v[144:159], v[180:183], v[200:203], v[144:159]
    ds_read_b64_tr_b16 v[180:181], v1 offset:33920
    ds_read_b64_tr_b16 v[182:183], v1 offset:34688
    buffer_load_dwordx4 v8, s[16:19], s27 offen offset:2048 lds
    s_waitcnt lgkmcnt(10)
    v_mfma_f32_32x32x16_bf16 v[64:79], v[160:163], v[204:207], v[64:79]
    s_waitcnt vmcnt(11)
    s_barrier
    ds_read_b64_tr_b16 v[160:161], v1 offset:36864
    ds_read_b64_tr_b16 v[162:163], v1 offset:37632
    s_waitcnt lgkmcnt(10)
    v_mfma_f32_32x32x16_bf16 v[80:95], v[164:167], v[204:207], v[80:95]
    ds_read_b64_tr_b16 v[164:165], v1 offset:43008
    ds_read_b64_tr_b16 v[166:167], v1 offset:43776
    s_add_u32 m0, s36, 16384
    s_mov_b32 s28, 896
    buffer_load_dwordx4 v9, s[12:15], s28 offen offset:0 lds
    s_waitcnt lgkmcnt(10)
    v_mfma_f32_32x32x16_bf16 v[96:111], v[168:171], v[204:207], v[96:111]
    ds_read_b64_tr_b16 v[168:169], v1 offset:36928
    ds_read_b64_tr_b16 v[170:171], v1 offset:37696
    buffer_load_dwordx4 v10, s[12:15], s28 offen offset:1024 lds
    s_waitcnt lgkmcnt(10)
    v_mfma_f32_32x32x16_bf16 v[112:127], v[172:175], v[204:207], v[112:127]
    ds_read_b64_tr_b16 v[172:173], v1 offset:43072
    ds_read_b64_tr_b16 v[174:175], v1 offset:43840
    s_mov_b32 s28, 15232
    s_nop 0
    buffer_load_dwordx4 v9, s[12:15], s28 offen offset:2048 lds
    s_waitcnt lgkmcnt(10)
    v_mfma_f32_32x32x16_bf16 v[128:143], v[176:179], v[204:207], v[128:143]
    ds_read_b64_tr_b16 v[176:177], v1 offset:36992
    ds_read_b64_tr_b16 v[178:179], v1 offset:37760
    buffer_load_dwordx4 v10, s[12:15], s28 offen offset:3072 lds
    s_waitcnt lgkmcnt(10)
    v_mfma_f32_32x32x16_bf16 v[144:159], v[180:183], v[204:207], v[144:159]
    ds_read_b64_tr_b16 v[180:181], v1 offset:43136
    ds_read_b64_tr_b16 v[182:183], v1 offset:43904
    s_waitcnt lgkmcnt(10)
    v_mfma_f32_32x32x16_bf16 v[64:79], v[160:163], v[208:211], v[64:79]
    ds_read_b64_tr_b16 v[160:161], v1 offset:39936
    ds_read_b64_tr_b16 v[162:163], v1 offset:40704
    s_waitcnt vmcnt(11)
    ds_read_b128 v[184:187], v2 offset:0
    ds_read_b128 v[188:191], v3 offset:0
    s_waitcnt lgkmcnt(12)
    v_mfma_f32_32x32x16_bf16 v[80:95], v[164:167], v[208:211], v[80:95]
    ds_read_b64_tr_b16 v[164:165], v1 offset:46080
    ds_read_b64_tr_b16 v[166:167], v1 offset:46848
    s_add_u32 m0, s35, 24576
    s_mov_b32 s27, 1232896
    buffer_load_dwordx4 v6, s[16:19], s27 offen offset:0 lds
    s_waitcnt lgkmcnt(12)
    v_mfma_f32_32x32x16_bf16 v[96:111], v[168:171], v[208:211], v[96:111]
    ds_read_b64_tr_b16 v[168:169], v1 offset:40000
    ds_read_b64_tr_b16 v[170:171], v1 offset:40768
    ds_read_b128 v[192:195], v4 offset:0
    s_waitcnt lgkmcnt(13)
    v_mfma_f32_32x32x16_bf16 v[112:127], v[172:175], v[208:211], v[112:127]
    ds_read_b64_tr_b16 v[172:173], v1 offset:46144
    ds_read_b64_tr_b16 v[174:175], v1 offset:46912
    buffer_load_dwordx4 v7, s[16:19], s27 offen offset:1024 lds
    s_waitcnt lgkmcnt(13)
    v_mfma_f32_32x32x16_bf16 v[128:143], v[176:179], v[208:211], v[128:143]
    ds_read_b64_tr_b16 v[176:177], v1 offset:40064
    ds_read_b64_tr_b16 v[178:179], v1 offset:40832
    ds_read_b128 v[196:199], v5 offset:0
    s_waitcnt lgkmcnt(14)
    v_mfma_f32_32x32x16_bf16 v[144:159], v[180:183], v[208:211], v[144:159]
    ds_read_b64_tr_b16 v[180:181], v1 offset:46208
    ds_read_b64_tr_b16 v[182:183], v1 offset:46976
    buffer_load_dwordx4 v8, s[16:19], s27 offen offset:2048 lds
    s_waitcnt lgkmcnt(14)
    v_mfma_f32_32x32x16_bf16 v[64:79], v[160:163], v[212:215], v[64:79]
    s_waitcnt vmcnt(11)
    s_barrier
    ds_read_b64_tr_b16 v[160:161], v1 offset:0
    ds_read_b64_tr_b16 v[162:163], v1 offset:768
    s_waitcnt lgkmcnt(12)
    v_mfma_f32_32x32x16_bf16 v[80:95], v[164:167], v[212:215], v[80:95]
    ds_read_b64_tr_b16 v[164:165], v1 offset:6144
    ds_read_b64_tr_b16 v[166:167], v1 offset:6912
    s_waitcnt lgkmcnt(12)
    v_mfma_f32_32x32x16_bf16 v[96:111], v[168:171], v[212:215], v[96:111]
    ds_read_b64_tr_b16 v[168:169], v1 offset:64
    ds_read_b64_tr_b16 v[170:171], v1 offset:832
    s_waitcnt lgkmcnt(11)
    v_mfma_f32_32x32x16_bf16 v[112:127], v[172:175], v[212:215], v[112:127]
    ds_read_b64_tr_b16 v[172:173], v1 offset:6208
    ds_read_b64_tr_b16 v[174:175], v1 offset:6976
    s_waitcnt lgkmcnt(11)
    v_mfma_f32_32x32x16_bf16 v[128:143], v[176:179], v[212:215], v[128:143]
    ds_read_b64_tr_b16 v[176:177], v1 offset:128
    ds_read_b64_tr_b16 v[178:179], v1 offset:896
    s_waitcnt lgkmcnt(10)
    v_mfma_f32_32x32x16_bf16 v[144:159], v[180:183], v[212:215], v[144:159]
    ds_read_b64_tr_b16 v[180:181], v1 offset:6272
    ds_read_b64_tr_b16 v[182:183], v1 offset:7040
    s_waitcnt vmcnt(10)
    v_readfirstlane_b32 s42, v54
    v_readfirstlane_b32 s43, v55
    s_cmp_lg_u32 s42, 0
    s_cbranch_scc1 Pnok_5
    s_mov_b32 s70, 8192
Pnsp_6:
    global_load_dwordx2 v[54:55], v59, s[46:47] sc1
    s_sub_u32 s70, s70, 1
    s_waitcnt vmcnt(0)
    v_readfirstlane_b32 s42, v54
    v_readfirstlane_b32 s43, v55
    s_cmp_lg_u32 s42, 0
    s_cbranch_scc1 Pnok_5
    s_cmp_lg_u32 s70, 0
    s_cbranch_scc1 Pnsp_6
Pnok_5:
    s_mov_b64 exec, s[72:73]
    buffer_load_dwordx2 v[54:55], v52, s[48:51], 0 offen sc1
    s_mov_b64 exec, -1
    s_waitcnt lgkmcnt(10)
    v_mfma_f32_32x32x16_bf16 v[64:79], v[160:163], v[184:187], v[64:79]
    ds_read_b64_tr_b16 v[160:161], v1 offset:3072
    ds_read_b64_tr_b16 v[162:163], v1 offset:3840
    s_waitcnt lgkmcnt(10)
    v_mfma_f32_32x32x16_bf16 v[80:95], v[164:167], v[184:187], v[80:95]
    ds_read_b64_tr_b16 v[164:165], v1 offset:9216
    ds_read_b64_tr_b16 v[166:167], v1 offset:9984
    s_add_u32 m0, s35, 36864
    s_mov_b32 s27, 1320960
    buffer_load_dwordx4 v6, s[16:19], s27 offen offset:0 lds
    s_waitcnt lgkmcnt(10)
    v_mfma_f32_32x32x16_bf16 v[96:111], v[168:171], v[184:187], v[96:111]
    ds_read_b64_tr_b16 v[168:169], v1 offset:3136
    ds_read_b64_tr_b16 v[170:171], v1 offset:3904
    s_waitcnt lgkmcnt(10)
    v_mfma_f32_32x32x16_bf16 v[112:127], v[172:175], v[184:187], v[112:127]
    ds_read_b64_tr_b16 v[172:173], v1 offset:9280
    ds_read_b64_tr_b16 v[174:175], v1 offset:10048
    buffer_load_dwordx4 v7, s[16:19], s27 offen offset:1024 lds
    s_waitcnt lgkmcnt(10)
    v_mfma_f32_32x32x16_bf16 v[128:143], v[176:179], v[184:187], v[128:143]
    ds_read_b64_tr_b16 v[176:177], v1 offset:3200
    ds_read_b64_tr_b16 v[178:179], v1 offset:3968
    s_waitcnt lgkmcnt(10)
    v_mfma_f32_32x32x16_bf16 v[144:159], v[180:183], v[184:187], v[144:159]
    ds_read_b64_tr_b16 v[180:181], v1 offset:9344
    ds_read_b64_tr_b16 v[182:183], v1 offset:10112
    buffer_load_dwordx4 v8, s[16:19], s27 offen offset:2048 lds
    s_waitcnt lgkmcnt(10)
    v_mfma_f32_32x32x16_bf16 v[64:79], v[160:163], v[188:191], v[64:79]
    s_waitcnt vmcnt(11)
    s_barrier
    ds_read_b64_tr_b16 v[160:161], v1 offset:12288
    ds_read_b64_tr_b16 v[162:163], v1 offset:13056
    s_waitcnt lgkmcnt(10)
    v_mfma_f32_32x32x16_bf16 v[80:95], v[164:167], v[188:191], v[80:95]
    ds_read_b64_tr_b16 v[164:165], v1 offset:18432
    ds_read_b64_tr_b16 v[166:167], v1 offset:19200
    s_waitcnt lgkmcnt(10)
    v_mfma_f32_32x32x16_bf16 v[96:111], v[168:171], v[188:191], v[96:111]
    ds_read_b64_tr_b16 v[168:169], v1 offset:12352
    ds_read_b64_tr_b16 v[170:171], v1 offset:13120
    s_waitcnt lgkmcnt(10)
    v_mfma_f32_32x32x16_bf16 v[112:127], v[172:175], v[188:191], v[112:127]
    ds_read_b64_tr_b16 v[172:173], v1 offset:18496
    ds_read_b64_tr_b16 v[174:175], v1 offset:19264
    s_waitcnt lgkmcnt(10)
    v_mfma_f32_32x32x16_bf16 v[128:143], v[176:179], v[188:191], v[128:143]
    ds_read_b64_tr_b16 v[176:177], v1 offset:12416
    ds_read_b64_tr_b16 v[178:179], v1 offset:13184
    s_waitcnt lgkmcnt(10)
    v_mfma_f32_32x32x16_bf16 v[144:159], v[180:183], v[188:191], v[144:159]
    ds_read_b64_tr_b16 v[180:181], v1 offset:18560
    ds_read_b64_tr_b16 v[182:183], v1 offset:19328
    s_waitcnt vmcnt(3)
    s_mov_b64 exec, s[72:73]
    v_cmp_ne_u64 vcc, s[42:43], v[54:55]
    s_mov_b64 exec, -1
    s_cbranch_vccz Pf1ok_7
    s_mov_b32 s70, 8192
Pf1sp_8:
    s_mov_b64 exec, s[72:73]
    buffer_load_dwordx2 v[54:55], v52, s[48:51], 0 offen sc1
    s_sub_u32 s70, s70, 1
    s_waitcnt vmcnt(0)
    v_cmp_ne_u64 vcc, s[42:43], v[54:55]
    s_mov_b64 exec, -1
    s_cbranch_vccz Pf1ok_7
    s_cmp_lg_u32 s70, 0
    s_cbranch_scc1 Pf1sp_8
Pf1ok_7:
    s_waitcnt lgkmcnt(10)
    v_mfma_f32_32x32x16_bf16 v[64:79], v[160:163], v[192:195], v[64:79]
    ds_read_b64_tr_b16 v[160:161], v1 offset:15360
    ds_read_b64_tr_b16 v[162:163], v1 offset:16128
    ds_read_b128 v[200:203], v2 offset:16384
    ds_read_b128 v[204:207], v3 offset:16384
    s_waitcnt lgkmcnt(12)
    v_mfma_f32_32x32x16_bf16 v[80:95], v[164:167], v[192:195], v[80:95]
    ds_read_b64_tr_b16 v[164:165], v1 offset:21504
    ds_read_b64_tr_b16 v[166:167], v1 offset:22272
    buffer_load_dwordx4 v[216:219], v40, s[48:51], 0 offen offset:0 sc1
    s_waitcnt lgkmcnt(12)
    v_mfma_f32_32x32x16_bf16 v[96:111], v[168:171], v[192:195], v[96:111]
    ds_read_b64_tr_b16 v[168:169], v1 offset:15424
    ds_read_b64_tr_b16 v[170:171], v1 offset:16192
    ds_read_b128 v[208:211], v4 offset:16384
    s_waitcnt lgkmcnt(13)
    v_mfma_f32_32x32x16_bf16 v[112:127], v[172:175], v[192:195], v[112:127]
    ds_read_b64_tr_b16 v[172:173], v1 offset:21568
    ds_read_b64_tr_b16 v[174:175], v1 offset:22336
    buffer_load_dwordx4 v[220:223], v42, s[48:51], 0 offen offset:0 sc1
    s_waitcnt lgkmcnt(13)
    v_mfma_f32_32x32x16_bf16 v[128:143], v[176:179], v[192:195], v[128:143]
    ds_read_b64_tr_b16 v[176:177], v1 offset:15488
    ds_read_b64_tr_b16 v[178:179], v1 offset:16256
    ds_read_b128 v[212:215], v5 offset:16384
    s_waitcnt lgkmcnt(14)
    v_mfma_f32_32x32x16_bf16 v[144:159], v[180:183], v[192:195], v[144:159]
    ds_read_b64_tr_b16 v[180:181], v1 offset:21632
    ds_read_b64_tr_b16 v[182:183], v1 offset:22400
    buffer_load_dwordx4 v[224:227], v40, s[48:51], 0 offen offset:1024 sc1
    s_waitcnt lgkmcnt(14)
    v_mfma_f32_32x32x16_bf16 v[64:79], v[160:163], v[196:199], v[64:79]
    s_barrier
    ds_read_b64_tr_b16 v[160:161], v1 offset:24576
    ds_read_b64_tr_b16 v[162:163], v1 offset:25344
    s_waitcnt lgkmcnt(12)
    v_mfma_f32_32x32x16_bf16 v[80:95], v[164:167], v[196:199], v[80:95]
    ds_read_b64_tr_b16 v[164:165], v1 offset:30720
    ds_read_b64_tr_b16 v[166:167], v1 offset:31488
    buffer_load_dwordx4 v[228:231], v42, s[48:51], 0 offen offset:1024 sc1
    s_waitcnt lgkmcnt(12)
    v_mfma_f32_32x32x16_bf16 v[96:111], v[168:171], v[196:199], v[96:111]
    ds_read_b64_tr_b16 v[168:169], v1 offset:24640
    ds_read_b64_tr_b16 v[170:171], v1 offset:25408
    s_waitcnt lgkmcnt(11)
    v_mfma_f32_32x32x16_bf16 v[112:127], v[172:175], v[196:199], v[112:127]
    ds_read_b64_tr_b16 v[172:173], v1 offset:30784
    ds_read_b64_tr_b16 v[174:175], v1 offset:31552
    buffer_load_dwordx4 v[232:235], v40, s[48:51], 0 offen offset:2048 sc1
    s_waitcnt lgkmcnt(11)
    v_mfma_f32_32x32x16_bf16 v[128:143], v[176:179], v[196:199], v[128:143]
    ds_read_b64_tr_b16 v[176:177], v1 offset:24704
    ds_read_b64_tr_b16 v[178:179], v1 offset:25472
    s_waitcnt lgkmcnt(10)
    v_mfma_f32_32x32x16_bf16 v[144:159], v[180:183], v[196:199], v[144:159]
    ds_read_b64_tr_b16 v[180:181], v1 offset:30848
    ds_read_b64_tr_b16 v[182:183], v1 offset:31616
    buffer_load_dwordx4 v[236:239], v42, s[48:51], 0 offen offset:2048 sc1
    s_waitcnt lgkmcnt(10)
    v_mfma_f32_32x32x16_bf16 v[64:79], v[160:163], v[200:203], v[64:79]
    ds_read_b64_tr_b16 v[160:161], v1 offset:27648
    ds_read_b64_tr_b16 v[162:163], v1 offset:28416
    s_waitcnt lgkmcnt(10)
    v_mfma_f32_32x32x16_bf16 v[80:95], v[164:167], v[200:203], v[80:95]
    ds_read_b64_tr_b16 v[164:165], v1 offset:33792
    ds_read_b64_tr_b16 v[166:167], v1 offset:34560
    buffer_load_dwordx4 v[240:243], v40, s[48:51], 0 offen offset:3072 sc1
    s_waitcnt lgkmcnt(10)
    v_mfma_f32_32x32x16_bf16 v[96:111], v[168:171], v[200:203], v[96:111]
    ds_read_b64_tr_b16 v[168:169], v1 offset:27712
    ds_read_b64_tr_b16 v[170:171], v1 offset:28480
    s_waitcnt lgkmcnt(10)
    v_mfma_f32_32x32x16_bf16 v[112:127], v[172:175], v[200:203], v[112:127]
    ds_read_b64_tr_b16 v[172:173], v1 offset:33856
    ds_read_b64_tr_b16 v[174:175], v1 offset:34624
    buffer_load_dwordx4 v[244:247], v42, s[48:51], 0 offen offset:3072 sc1
    s_waitcnt lgkmcnt(10)
    v_mfma_f32_32x32x16_bf16 v[128:143], v[176:179], v[200:203], v[128:143]
    ds_read_b64_tr_b16 v[176:177], v1 offset:27776
    ds_read_b64_tr_b16 v[178:179], v1 offset:28544
    s_waitcnt lgkmcnt(10)
    v_mfma_f32_32x32x16_bf16 v[144:159], v[180:183], v[200:203], v[144:159]
    ds_read_b64_tr_b16 v[180:181], v1 offset:33920
    ds_read_b64_tr_b16 v[182:183], v1 offset:34688
    s_mov_b32 s64, 4096
    buffer_load_dwordx4 v[248:251], v40, s[48:51], s64 offen offset:0 sc1
    s_waitcnt lgkmcnt(10)
    v_mfma_f32_32x32x16_bf16 v[64:79], v[160:163], v[204:207], v[64:79]
    s_waitcnt vmcnt(9)
    s_barrier
    ds_read_b64_tr_b16 v[160:161], v1 offset:36864
    ds_read_b64_tr_b16 v[162:163], v1 offset:37632
    s_waitcnt lgkmcnt(10)
    v_mfma_f32_32x32x16_bf16 v[80:95], v[164:167], v[204:207], v[80:95]
    ds_read_b64_tr_b16 v[164:165], v1 offset:43008
    ds_read_b64_tr_b16 v[166:167], v1 offset:43776
    buffer_load_dwordx4 v[252:255], v42, s[48:51], s64 offen offset:0 sc1
    s_waitcnt lgkmcnt(10)
    v_mfma_f32_32x32x16_bf16 v[96:111], v[168:171], v[204:207], v[96:111]
    ds_read_b64_tr_b16 v[168:169], v1 offset:36928
    ds_read_b64_tr_b16 v[170:171], v1 offset:37696
    s_waitcnt lgkmcnt(10)
    v_mfma_f32_32x32x16_bf16 v[112:127], v[172:175], v[204:207], v[112:127]
    ds_read_b64_tr_b16 v[172:173], v1 offset:43072
    ds_read_b64_tr_b16 v[174:175], v1 offset:43840
    buffer_load_dwordx4 v[16:19], v40, s[48:51], s64 offen offset:1024 sc1
    s_waitcnt lgkmcnt(10)
    v_mfma_f32_32x32x16_bf16 v[128:143], v[176:179], v[204:207], v[128:143]
    ds_read_b64_tr_b16 v[176:177], v1 offset:36992
    ds_read_b64_tr_b16 v[178:179], v1 offset:37760
    s_waitcnt lgkmcnt(10)
    v_mfma_f32_32x32x16_bf16 v[144:159], v[180:183], v[204:207], v[144:159]
    ds_read_b64_tr_b16 v[180:181], v1 offset:43136
    ds_read_b64_tr_b16 v[182:183], v1 offset:43904
    buffer_load_dwordx4 v[20:23], v42, s[48:51], s64 offen offset:1024 sc1
    s_waitcnt lgkmcnt(10)
    v_mfma_f32_32x32x16_bf16 v[64:79], v[160:163], v[208:211], v[64:79]
    ds_read_b64_tr_b16 v[160:161], v1 offset:39936
    ds_read_b64_tr_b16 v[162:163], v1 offset:40704
    s_waitcnt lgkmcnt(10)
    v_mfma_f32_32x32x16_bf16 v[80:95], v[164:167], v[208:211], v[80:95]
    ds_read_b64_tr_b16 v[164:165], v1 offset:46080
    ds_read_b64_tr_b16 v[166:167], v1 offset:46848
    buffer_load_dwordx4 v[24:27], v40, s[48:51], s64 offen offset:2048 sc1
    s_waitcnt lgkmcnt(10)
    v_mfma_f32_32x32x16_bf16 v[96:111], v[168:171], v[208:211], v[96:111]
    ds_read_b64_tr_b16 v[168:169], v1 offset:40000
    ds_read_b64_tr_b16 v[170:171], v1 offset:40768
    s_waitcnt lgkmcnt(10)
    v_mfma_f32_32x32x16_bf16 v[112:127], v[172:175], v[208:211], v[112:127]
    ds_read_b64_tr_b16 v[172:173], v1 offset:46144
    ds_read_b64_tr_b16 v[174:175], v1 offset:46912
    buffer_load_dwordx4 v[28:31], v42, s[48:51], s64 offen offset:2048 sc1
    s_waitcnt lgkmcnt(10)
    v_mfma_f32_32x32x16_bf16 v[128:143], v[176:179], v[208:211], v[128:143]
    ds_read_b64_tr_b16 v[176:177], v1 offset:40064
    ds_read_b64_tr_b16 v[178:179], v1 offset:40832
    s_waitcnt lgkmcnt(10)
    v_mfma_f32_32x32x16_bf16 v[144:159], v[180:183], v[208:211], v[144:159]
    ds_read_b64_tr_b16 v[180:181], v1 offset:46208
    ds_read_b64_tr_b16 v[182:183], v1 offset:46976
    buffer_load_dwordx4 v[32:35], v40, s[48:51], s64 offen offset:3072 sc1
    s_waitcnt lgkmcnt(10)
    v_mfma_f32_32x32x16_bf16 v[64:79], v[160:163], v[212:215], v[64:79]
    s_waitcnt lgkmcnt(8)
    v_mfma_f32_32x32x16_bf16 v[80:95], v[164:167], v[212:215], v[80:95]
    buffer_load_dwordx4 v[36:39], v42, s[48:51], s64 offen offset:3072 sc1
    s_waitcnt lgkmcnt(6)
    v_mfma_f32_32x32x16_bf16 v[96:111], v[168:171], v[212:215], v[96:111]
    s_waitcnt lgkmcnt(4)
    v_mfma_f32_32x32x16_bf16 v[112:127], v[172:175], v[212:215], v[112:127]
    s_waitcnt lgkmcnt(2)
    v_mfma_f32_32x32x16_bf16 v[128:143], v[176:179], v[212:215], v[128:143]
    s_waitcnt lgkmcnt(0)
    v_mfma_f32_32x32x16_bf16 v[144:159], v[180:183], v[212:215], v[144:159]
    s_barrier
    s_nop 7
    s_nop 3
    v_max_f32 v64, 0, v64
    v_max_f32 v65, 0, v65
    v_max_f32 v66, 0, v66
    v_max_f32 v67, 0, v67
    v_max_f32 v68, 0, v68
    v_max_f32 v69, 0, v69
    v_max_f32 v70, 0, v70
    v_max_f32 v71, 0, v71
    v_max_f32 v72, 0, v72
    v_max_f32 v73, 0, v73
    v_max_f32 v74, 0, v74
    v_max_f32 v75, 0, v75
    v_max_f32 v76, 0, v76
    v_max_f32 v77, 0, v77
    v_max_f32 v78, 0, v78
    v_max_f32 v79, 0, v79
    v_mul_f32 v64, v64, v80
    v_mul_f32 v65, v65, v81
    v_mul_f32 v66, v66, v82
    v_mul_f32 v67, v67, v83
    v_mul_f32 v68, v68, v84
    v_mul_f32 v69, v69, v85
    v_mul_f32 v70, v70, v86
    v_mul_f32 v71, v71, v87
    v_mul_f32 v72, v72, v88
    v_mul_f32 v73, v73, v89
    v_mul_f32 v74, v74, v90
    v_mul_f32 v75, v75, v91
    v_mul_f32 v76, v76, v92
    v_mul_f32 v77, v77, v93
    v_mul_f32 v78, v78, v94
    v_mul_f32 v79, v79, v95
    v_cvt_pk_bf16_f32 v160, v64, v65
    v_cvt_pk_bf16_f32 v161, v66, v67
    v_cvt_pk_bf16_f32 v162, v68, v69
    v_cvt_pk_bf16_f32 v163, v70, v71
    v_cvt_pk_bf16_f32 v164, v72, v73
    v_cvt_pk_bf16_f32 v165, v74, v75
    v_cvt_pk_bf16_f32 v166, v76, v77
    v_cvt_pk_bf16_f32 v167, v78, v79
    s_nop 0
    v_permlane32_swap_b32 v160, v162
    v_permlane32_swap_b32 v161, v163
    s_nop 0
    buffer_store_dwordx4 v[160:163], v11, s[20:23], 0 offen offset:0 sc1
    s_nop 0
    v_permlane32_swap_b32 v164, v166
    v_permlane32_swap_b32 v165, v167
    s_nop 0
    buffer_store_dwordx4 v[164:167], v11, s[20:23], 0 offen offset:1024 sc1
    s_cmp_eq_u32 s25, 14
    s_cbranch_scc1 G1done_9
    v_max_f32 v96, 0, v96
    v_max_f32 v97, 0, v97
    v_max_f32 v98, 0, v98
    v_max_f32 v99, 0, v99
    v_max_f32 v100, 0, v100
    v_max_f32 v101, 0, v101
    v_max_f32 v102, 0, v102
    v_max_f32 v103, 0, v103
    v_max_f32 v104, 0, v104
    v_max_f32 v105, 0, v105
    v_max_f32 v106, 0, v106
    v_max_f32 v107, 0, v107
    v_max_f32 v108, 0, v108
    v_max_f32 v109, 0, v109
    v_max_f32 v110, 0, v110
    v_max_f32 v111, 0, v111
    v_mul_f32 v96, v96, v112
    v_mul_f32 v97, v97, v113
    v_mul_f32 v98, v98, v114
    v_mul_f32 v99, v99, v115
    v_mul_f32 v100, v100, v116
    v_mul_f32 v101, v101, v117
    v_mul_f32 v102, v102, v118
    v_mul_f32 v103, v103, v119
    v_mul_f32 v104, v104, v120
    v_mul_f32 v105, v105, v121
    v_mul_f32 v106, v106, v122
    v_mul_f32 v107, v107, v123
    v_mul_f32 v108, v108, v124
    v_mul_f32 v109, v109, v125
    v_mul_f32 v110, v110, v126
    v_mul_f32 v111, v111, v127
    v_cvt_pk_bf16_f32 v168, v96, v97
    v_cvt_pk_bf16_f32 v169, v98, v99
    v_cvt_pk_bf16_f32 v170, v100, v101
    v_cvt_pk_bf16_f32 v171, v102, v103
    v_cvt_pk_bf16_f32 v172, v104, v105
    v_cvt_pk_bf16_f32 v173, v106, v107
    v_cvt_pk_bf16_f32 v174, v108, v109
    v_cvt_pk_bf16_f32 v175, v110, v111
    s_nop 0
    v_permlane32_swap_b32 v168, v170
    v_permlane32_swap_b32 v169, v171
    s_nop 0
    buffer_store_dwordx4 v[168:171], v11, s[20:23], 0 offen offset:2048 sc1
    s_nop 0
    v_permlane32_swap_b32 v172, v174
    v_permlane32_swap_b32 v173, v175
    s_nop 0
    buffer_store_dwordx4 v[172:175], v11, s[20:23], 0 offen offset:3072 sc1
    v_max_f32 v128, 0, v128
    v_max_f32 v129, 0, v129
    v_max_f32 v130, 0, v130
    v_max_f32 v131, 0, v131
    v_max_f32 v132, 0, v132
    v_max_f32 v133, 0, v133
    v_max_f32 v134, 0, v134
    v_max_f32 v135, 0, v135
    v_max_f32 v136, 0, v136
    v_max_f32 v137, 0, v137
    v_max_f32 v138, 0, v138
    v_max_f32 v139, 0, v139
    v_max_f32 v140, 0, v140
    v_max_f32 v141, 0, v141
    v_max_f32 v142, 0, v142
    v_max_f32 v143, 0, v143
    v_mul_f32 v128, v128, v144
    v_mul_f32 v129, v129, v145
    v_mul_f32 v130, v130, v146
    v_mul_f32 v131, v131, v147
    v_mul_f32 v132, v132, v148
    v_mul_f32 v133, v133, v149
    v_mul_f32 v134, v134, v150
    v_mul_f32 v135, v135, v151
    v_mul_f32 v136, v136, v152
    v_mul_f32 v137, v137, v153
    v_mul_f32 v138, v138, v154
    v_mul_f32 v139, v139, v155
    v_mul_f32 v140, v140, v156
    v_mul_f32 v141, v141, v157
    v_mul_f32 v142, v142, v158
    v_mul_f32 v143, v143, v159
    v_cvt_pk_bf16_f32 v176, v128, v129
    v_cvt_pk_bf16_f32 v177, v130, v131
    v_cvt_pk_bf16_f32 v178, v132, v133
    v_cvt_pk_bf16_f32 v179, v134, v135
    v_cvt_pk_bf16_f32 v180, v136, v137
    v_cvt_pk_bf16_f32 v181, v138, v139
    v_cvt_pk_bf16_f32 v182, v140, v141
    v_cvt_pk_bf16_f32 v183, v142, v143
    s_nop 0
    v_permlane32_swap_b32 v176, v178
    v_permlane32_swap_b32 v177, v179
    s_nop 0
    s_mov_b32 s30, 4096
    buffer_store_dwordx4 v[176:179], v11, s[20:23], s30 offen offset:0 sc1
    s_nop 0
    v_permlane32_swap_b32 v180, v182
    v_permlane32_swap_b32 v181, v183
    s_nop 0
    s_mov_b32 s30, 5120
    buffer_store_dwordx4 v[180:183], v11, s[20:23], s30 offen offset:0 sc1
G1done_9:
    s_mov_b32 s64, 8192
    buffer_load_dwordx4 v[176:179], v40, s[48:51], s64 offen offset:0 sc1
    buffer_load_dwordx4 v[180:183], v42, s[48:51], s64 offen offset:0 sc1
    buffer_load_dwordx4 v[184:187], v40, s[48:51], s64 offen offset:1024 sc1
    buffer_load_dwordx4 v[188:191], v42, s[48:51], s64 offen offset:1024 sc1
    buffer_load_dwordx4 v[192:195], v40, s[48:51], s64 offen offset:2048 sc1
    buffer_load_dwordx4 v[196:199], v42, s[48:51], s64 offen offset:2048 sc1
    buffer_load_dwordx4 v[200:203], v40, s[48:51], s64 offen offset:3072 sc1
    buffer_load_dwordx4 v[204:207], v42, s[48:51], s64 offen offset:3072 sc1
    buffer_load_dwordx4 v[208:211], v40, s[48:51], s59 offen offset:1024 sc1
    buffer_load_dwordx4 v[212:215], v42, s[48:51], s59 offen offset:1024 sc1
    s_mov_b32 s64, 12288
    s_add_u32 m0, s65, 0
    s_nop 0
    buffer_load_dwordx4 v40, s[48:51], s64 offen offset:0 sc1 lds
    buffer_load_dwordx4 v40, s[48:51], s64 offen offset:1024 sc1 lds
    buffer_load_dwordx4 v40, s[48:51], s64 offen offset:2048 sc1 lds
    buffer_load_dwordx4 v40, s[48:51], s64 offen offset:3072 sc1 lds
    s_waitcnt vmcnt(14)
    v_mov_b32 v54, s42
    v_mov_b32 v55, s43
    s_mov_b64 exec, 1
    buffer_store_dwordx2 v[54:55], v58, s[48:51], 0 offen sc1
    s_mov_b64 exec, -1
    s_mov_b32 s64, 16384
    s_add_u32 m0, s65, 4096
    s_nop 0
    buffer_load_dwordx4 v40, s[48:51], s64 offen offset:0 sc1 lds
    buffer_load_dwordx4 v40, s[48:51], s64 offen offset:1024 sc1 lds
    buffer_load_dwordx4 v40, s[48:51], s64 offen offset:2048 sc1 lds
    buffer_load_dwordx4 v40, s[48:51], s64 offen offset:3072 sc1 lds
    s_mov_b32 s64, 20480
    s_add_u32 m0, s65, 8192
    s_nop 0
    buffer_load_dwordx4 v40, s[48:51], s64 offen offset:0 sc1 lds
    s_mov_b32 s64, 12288
    s_add_u32 m0, s65, 9216
    s_nop 0
    buffer_load_dwordx4 v42, s[48:51], s64 offen offset:0 sc1 lds
    buffer_load_dwordx4 v42, s[48:51], s64 offen offset:1024 sc1 lds
    buffer_load_dwordx4 v42, s[48:51], s64 offen offset:2048 sc1 lds
    buffer_load_dwordx4 v42, s[48:51], s64 offen offset:3072 sc1 lds
    s_mov_b32 s64, 16384
    s_add_u32 m0, s65, 13312
    s_nop 0
    buffer_load_dwordx4 v42, s[48:51], s64 offen offset:0 sc1 lds
    buffer_load_dwordx4 v42, s[48:51], s64 offen offset:1024 sc1 lds
    buffer_load_dwordx4 v42, s[48:51], s64 offen offset:2048 sc1 lds
    buffer_load_dwordx4 v42, s[48:51], s64 offen offset:3072 sc1 lds
    s_mov_b32 s64, 20480
    s_add_u32 m0, s65, 17408
    s_nop 0
    buffer_load_dwordx4 v42, s[48:51], s64 offen offset:0 sc1 lds
    s_branch Pjoin_10
Pidle_1:
    s_mov_b32 s70, 8192
Pisp_12:
    global_load_dwordx2 v[54:55], v59, s[46:47] sc1
    s_sub_u32 s70, s70, 1
    s_waitcnt vmcnt(0)
    v_readfirstlane_b32 s42, v54
    v_readfirstlane_b32 s43, v55
    s_cmp_lg_u32 s42, 0
    s_cbranch_scc1 Piok_11
    s_cmp_lg_u32 s70, 0
    s_cbranch_scc1 Pisp_12
Piok_11:
    s_mov_b32 s70, 8192
Pi1sp_14:
    s_mov_b64 exec, s[72:73]
    buffer_load_dwordx2 v[54:55], v52, s[48:51], 0 offen sc1
    s_sub_u32 s70, s70, 1
    s_waitcnt vmcnt(0)
    v_cmp_ne_u64 vcc, s[42:43], v[54:55]
    s_mov_b64 exec, -1
    s_cbranch_vccz Pi1ok_13
    s_cmp_lg_u32 s70, 0
    s_cbranch_scc1 Pi1sp_14
Pi1ok_13:
    buffer_load_dwordx4 v[216:219], v40, s[48:51], 0 offen offset:0 sc1
    buffer_load_dwordx4 v[220:223], v42, s[48:51], 0 offen offset:0 sc1
    buffer_load_dwordx4 v[224:227], v40, s[48:51], 0 offen offset:1024 sc1
    buffer_load_dwordx4 v[228:231], v42, s[48:51], 0 offen offset:1024 sc1
    buffer_load_dwordx4 v[232:235], v40, s[48:51], 0 offen offset:2048 sc1
    buffer_load_dwordx4 v[236:239], v42, s[48:51], 0 offen offset:2048 sc1
    buffer_load_dwordx4 v[240:243], v40, s[48:51], 0 offen offset:3072 sc1
    buffer_load_dwordx4 v[244:247], v42, s[48:51], 0 offen offset:3072 sc1
    s_mov_b32 s64, 4096
    buffer_load_dwordx4 v[248:251], v40, s[48:51], s64 offen offset:0 sc1
    buffer_load_dwordx4 v[252:255], v42, s[48:51], s64 offen offset:0 sc1
    buffer_load_dwordx4 v[16:19], v40, s[48:51], s64 offen offset:1024 sc1
    buffer_load_dwordx4 v[20:23], v42, s[48:51], s64 offen offset:1024 sc1
    buffer_load_dwordx4 v[24:27], v40, s[48:51], s64 offen offset:2048 sc1
    buffer_load_dwordx4 v[28:31], v42, s[48:51], s64 offen offset:2048 sc1
    buffer_load_dwordx4 v[32:35], v40, s[48:51], s64 offen offset:3072 sc1
    buffer_load_dwordx4 v[36:39], v42, s[48:51], s64 offen offset:3072 sc1
    s_mov_b32 s64, 8192
    buffer_load_dwordx4 v[176:179], v40, s[48:51], s64 offen offset:0 sc1
    buffer_load_dwordx4 v[180:183], v42, s[48:51], s64 offen offset:0 sc1
    buffer_load_dwordx4 v[184:187], v40, s[48:51], s64 offen offset:1024 sc1
    buffer_load_dwordx4 v[188:191], v42, s[48:51], s64 offen offset:1024 sc1
    buffer_load_dwordx4 v[192:195], v40, s[48:51], s64 offen offset:2048 sc1
    buffer_load_dwordx4 v[196:199], v42, s[48:51], s64 offen offset:2048 sc1
    buffer_load_dwordx4 v[200:203], v40, s[48:51], s64 offen offset:3072 sc1
    buffer_load_dwordx4 v[204:207], v42, s[48:51], s64 offen offset:3072 sc1
    buffer_load_dwordx4 v[208:211], v40, s[48:51], s59 offen offset:1024 sc1
    buffer_load_dwordx4 v[212:215], v42, s[48:51], s59 offen offset:1024 sc1
    s_mov_b32 s64, 12288
    s_add_u32 m0, s65, 0
    s_nop 0
    buffer_load_dwordx4 v40, s[48:51], s64 offen offset:0 sc1 lds
    buffer_load_dwordx4 v40, s[48:51], s64 offen offset:1024 sc1 lds
    buffer_load_dwordx4 v40, s[48:51], s64 offen offset:2048 sc1 lds
    buffer_load_dwordx4 v40, s[48:51], s64 offen offset:3072 sc1 lds
    s_mov_b32 s64, 16384
    s_add_u32 m0, s65, 4096
    s_nop 0
    buffer_load_dwordx4 v40, s[48:51], s64 offen offset:0 sc1 lds
    buffer_load_dwordx4 v40, s[48:51], s64 offen offset:1024 sc1 lds
    buffer_load_dwordx4 v40, s[48:51], s64 offen offset:2048 sc1 lds
    buffer_load_dwordx4 v40, s[48:51], s64 offen offset:3072 sc1 lds
    s_mov_b32 s64, 20480
    s_add_u32 m0, s65, 8192
    s_nop 0
    buffer_load_dwordx4 v40, s[48:51], s64 offen offset:0 sc1 lds
    s_mov_b32 s64, 12288
    s_add_u32 m0, s65, 9216
    s_nop 0
    buffer_load_dwordx4 v42, s[48:51], s64 offen offset:0 sc1 lds
    buffer_load_dwordx4 v42, s[48:51], s64 offen offset:1024 sc1 lds
    buffer_load_dwordx4 v42, s[48:51], s64 offen offset:2048 sc1 lds
    buffer_load_dwordx4 v42, s[48:51], s64 offen offset:3072 sc1 lds
    s_mov_b32 s64, 16384
    s_add_u32 m0, s65, 13312
    s_nop 0
    buffer_load_dwordx4 v42, s[48:51], s64 offen offset:0 sc1 lds
    buffer_load_dwordx4 v42, s[48:51], s64 offen offset:1024 sc1 lds
    buffer_load_dwordx4 v42, s[48:51], s64 offen offset:2048 sc1 lds
    buffer_load_dwordx4 v42, s[48:51], s64 offen offset:3072 sc1 lds
    s_mov_b32 s64, 20480
    s_add_u32 m0, s65, 17408
    s_nop 0
    buffer_load_dwordx4 v42, s[48:51], s64 offen offset:0 sc1 lds
Pjoin_10:
    s_setprio 2
    v_add_u32 v7, s65, v50
    s_mov_b32 s70, 8192
Pfhsp_16:
    s_mov_b64 exec, s[74:75]
    buffer_load_dwordx2 v[54:55], v51, s[48:51], 0 offen sc1
    s_sub_u32 s70, s70, 1
    s_waitcnt vmcnt(0)
    v_cmp_ne_u64 vcc, s[42:43], v[54:55]
    s_mov_b64 exec, -1
    s_cbranch_vccz Pfhok_15
    s_cmp_lg_u32 s70, 0
    s_cbranch_scc1 Pfhsp_16
Pfhok_15:
    buffer_load_dwordx4 v[128:131], v41, s[48:51], 0 offen offset:0 sc1
    buffer_load_dwordx4 v[132:135], v43, s[48:51], 0 offen offset:0 sc1
    buffer_load_dwordx4 v[136:139], v41, s[48:51], 0 offen offset:1024 sc1
    buffer_load_dwordx4 v[140:143], v43, s[48:51], 0 offen offset:1024 sc1
    buffer_load_dwordx4 v[144:147], v41, s[48:51], 0 offen offset:2048 sc1
    buffer_load_dwordx4 v[148:151], v43, s[48:51], 0 offen offset:2048 sc1
    buffer_load_dwordx4 v[152:155], v41, s[48:51], 0 offen offset:3072 sc1
    buffer_load_dwordx4 v[156:159], v43, s[48:51], 0 offen offset:3072 sc1
    s_mov_b32 s64, 4096
    buffer_load_dwordx4 v[160:163], v41, s[48:51], s64 offen offset:0 sc1
    buffer_load_dwordx4 v[164:167], v43, s[48:51], s64 offen offset:0 sc1
    buffer_load_dwordx4 v[168:171], v41, s[48:51], s64 offen offset:1024 sc1
    buffer_load_dwordx4 v[172:175], v43, s[48:51], s64 offen offset:1024 sc1
    s_waitcnt vmcnt(11)
    v_mfma_f32_32x32x16_bf16 v[64:79], v[216:219], v[128:131], 0
    v_mfma_f32_32x32x16_bf16 v[80:95], v[220:223], v[128:131], 0
    s_waitcnt vmcnt(10)
    v_mfma_f32_32x32x16_bf16 v[96:111], v[216:219], v[132:135], 0
    v_mfma_f32_32x32x16_bf16 v[112:127], v[220:223], v[132:135], 0
    buffer_load_dwordx4 v[216:219], v41, s[48:51], s64 offen offset:2048 sc1
    buffer_load_dwordx4 v[220:223], v43, s[48:51], s64 offen offset:2048 sc1
    buffer_load_dwordx4 v[128:131], v41, s[48:51], s64 offen offset:3072 sc1
    buffer_load_dwordx4 v[132:135], v43, s[48:51], s64 offen offset:3072 sc1
    s_waitcnt vmcnt(13)
    v_mfma_f32_32x32x16_bf16 v[64:79], v[224:227], v[136:139], v[64:79]
    v_mfma_f32_32x32x16_bf16 v[80:95], v[228:231], v[136:139], v[80:95]
    s_waitcnt vmcnt(12)
    v_mfma_f32_32x32x16_bf16 v[96:111], v[224:227], v[140:143], v[96:111]
    v_mfma_f32_32x32x16_bf16 v[112:127], v[228:231], v[140:143], v[112:127]
    s_mov_b32 s64, 8192
    buffer_load_dwordx4 v[224:227], v41, s[48:51], s64 offen offset:0 sc1
    buffer_load_dwordx4 v[228:231], v43, s[48:51], s64 offen offset:0 sc1
    buffer_load_dwordx4 v[136:139], v41, s[48:51], s64 offen offset:1024 sc1
    buffer_load_dwordx4 v[140:143], v43, s[48:51], s64 offen offset:1024 sc1
    s_waitcnt vmcnt(15)
    v_mfma_f32_32x32x16_bf16 v[64:79], v[232:235], v[144:147], v[64:79]
    v_mfma_f32_32x32x16_bf16 v[80:95], v[236:239], v[144:147], v[80:95]
    s_waitcnt vmcnt(14)
    v_mfma_f32_32x32x16_bf16 v[96:111], v[232:235], v[148:151], v[96:111]
    v_mfma_f32_32x32x16_bf16 v[112:127], v[236:239], v[148:151], v[112:127]
    buffer_load_dwordx4 v[232:235], v41, s[48:51], s64 offen offset:2048 sc1
    buffer_load_dwordx4 v[236:239], v43, s[48:51], s64 offen offset:2048 sc1
    buffer_load_dwordx4 v[144:147], v41, s[48:51], s64 offen offset:3072 sc1
    buffer_load_dwordx4 v[148:151], v43, s[48:51], s64 offen offset:3072 sc1
    s_waitcnt vmcnt(17)
    v_mfma_f32_32x32x16_bf16 v[64:79], v[240:243], v[152:155], v[64:79]
    v_mfma_f32_32x32x16_bf16 v[80:95], v[244:247], v[152:155], v[80:95]
    s_waitcnt vmcnt(16)
    v_mfma_f32_32x32x16_bf16 v[96:111], v[240:243], v[156:159], v[96:111]
    v_mfma_f32_32x32x16_bf16 v[112:127], v[244:247], v[156:159], v[112:127]
    s_mov_b32 s64, 12288
    buffer_load_dwordx4 v[240:243], v41, s[48:51], s64 offen offset:0 sc1
    buffer_load_dwordx4 v[244:247], v43, s[48:51], s64 offen offset:0 sc1
    buffer_load_dwordx4 v[152:155], v41, s[48:51], s64 offen offset:1024 sc1
    buffer_load_dwordx4 v[156:159], v43, s[48:51], s64 offen offset:1024 sc1
    s_waitcnt vmcnt(19)
    v_mfma_f32_32x32x16_bf16 v[64:79], v[248:251], v[160:163], v[64:79]
    v_mfma_f32_32x32x16_bf16 v[80:95], v[252:255], v[160:163], v[80:95]
    s_waitcnt vmcnt(18)
    v_mfma_f32_32x32x16_bf16 v[96:111], v[248:251], v[164:167], v[96:111]
    v_mfma_f32_32x32x16_bf16 v[112:127], v[252:255], v[164:167], v[112:127]
    buffer_load_dwordx4 v[248:251], v41, s[48:51], s64 offen offset:2048 sc1
    buffer_load_dwordx4 v[252:255], v43, s[48:51], s64 offen offset:2048 sc1
    buffer_load_dwordx4 v[160:163], v41, s[48:51], s64 offen offset:3072 sc1
    buffer_load_dwordx4 v[164:167], v43, s[48:51], s64 offen offset:3072 sc1
    s_waitcnt vmcnt(21)
    v_mfma_f32_32x32x16_bf16 v[64:79], v[16:19], v[168:171], v[64:79]
    v_mfma_f32_32x32x16_bf16 v[80:95], v[20:23], v[168:171], v[80:95]
    s_waitcnt vmcnt(20)
    v_mfma_f32_32x32x16_bf16 v[96:111], v[16:19], v[172:175], v[96:111]
    v_mfma_f32_32x32x16_bf16 v[112:127], v[20:23], v[172:175], v[112:127]
    s_mov_b32 s64, 16384
    buffer_load_dwordx4 v[16:19], v41, s[48:51], s64 offen offset:0 sc1
    buffer_load_dwordx4 v[20:23], v43, s[48:51], s64 offen offset:0 sc1
    buffer_load_dwordx4 v[168:171], v41, s[48:51], s64 offen offset:1024 sc1
    buffer_load_dwordx4 v[172:175], v43, s[48:51], s64 offen offset:1024 sc1
    s_waitcnt vmcnt(23)
    v_mfma_f32_32x32x16_bf16 v[64:79], v[24:27], v[216:219], v[64:79]
    v_mfma_f32_32x32x16_bf16 v[80:95], v[28:31], v[216:219], v[80:95]
    s_waitcnt vmcnt(22)
    v_mfma_f32_32x32x16_bf16 v[96:111], v[24:27], v[220:223], v[96:111]
    v_mfma_f32_32x32x16_bf16 v[112:127], v[28:31], v[220:223], v[112:127]
    buffer_load_dwordx4 v[24:27], v41, s[48:51], s64 offen offset:2048 sc1
    buffer_load_dwordx4 v[28:31], v43, s[48:51], s64 offen offset:2048 sc1
    buffer_load_dwordx4 v[216:219], v41, s[48:51], s64 offen offset:3072 sc1
    buffer_load_dwordx4 v[220:223], v43, s[48:51], s64 offen offset:3072 sc1
    s_waitcnt vmcnt(25)
    v_mfma_f32_32x32x16_bf16 v[64:79], v[32:35], v[128:131], v[64:79]
    v_mfma_f32_32x32x16_bf16 v[80:95], v[36:39], v[128:131], v[80:95]
    s_waitcnt vmcnt(24)
    v_mfma_f32_32x32x16_bf16 v[96:111], v[32:35], v[132:135], v[96:111]
    v_mfma_f32_32x32x16_bf16 v[112:127], v[36:39], v[132:135], v[112:127]
    s_mov_b32 s64, 20480
    buffer_load_dwordx4 v[32:35], v41, s[48:51], s64 offen offset:0 sc1
    buffer_load_dwordx4 v[36:39], v43, s[48:51], s64 offen offset:0 sc1
    buffer_load_dwordx4 v[128:131], v41, s[48:51], s59 offen offset:1024 sc1
    buffer_load_dwordx4 v[132:135], v43, s[48:51], s59 offen offset:1024 sc1
    s_waitcnt vmcnt(27)
    v_mfma_f32_32x32x16_bf16 v[64:79], v[176:179], v[224:227], v[64:79]
    v_mfma_f32_32x32x16_bf16 v[80:95], v[180:183], v[224:227], v[80:95]
    s_waitcnt vmcnt(26)
    v_mfma_f32_32x32x16_bf16 v[96:111], v[176:179], v[228:231], v[96:111]
    v_mfma_f32_32x32x16_bf16 v[112:127], v[180:183], v[228:231], v[112:127]
    s_waitcnt vmcnt(25)
    v_mfma_f32_32x32x16_bf16 v[64:79], v[184:187], v[136:139], v[64:79]
    v_mfma_f32_32x32x16_bf16 v[80:95], v[188:191], v[136:139], v[80:95]
    s_waitcnt vmcnt(24)
    v_mfma_f32_32x32x16_bf16 v[96:111], v[184:187], v[140:143], v[96:111]
    v_mfma_f32_32x32x16_bf16 v[112:127], v[188:191], v[140:143], v[112:127]
    s_waitcnt vmcnt(23)
    v_mfma_f32_32x32x16_bf16 v[64:79], v[192:195], v[232:235], v[64:79]
    v_mfma_f32_32x32x16_bf16 v[80:95], v[196:199], v[232:235], v[80:95]
    s_waitcnt vmcnt(22)
    v_mfma_f32_32x32x16_bf16 v[96:111], v[192:195], v[236:239], v[96:111]
    v_mfma_f32_32x32x16_bf16 v[112:127], v[196:199], v[236:239], v[112:127]
    ds_read_b128 v[176:179], v7 offset:0
    ds_read_b128 v[180:183], v7 offset:9216
    s_waitcnt vmcnt(21)
    v_mfma_f32_32x32x16_bf16 v[64:79], v[200:203], v[144:147], v[64:79]
    v_mfma_f32_32x32x16_bf16 v[80:95], v[204:207], v[144:147], v[80:95]
    s_waitcnt vmcnt(20)
    v_mfma_f32_32x32x16_bf16 v[96:111], v[200:203], v[148:151], v[96:111]
    v_mfma_f32_32x32x16_bf16 v[112:127], v[204:207], v[148:151], v[112:127]
    ds_read_b128 v[224:227], v7 offset:1024
    ds_read_b128 v[228:231], v7 offset:10240
    s_waitcnt lgkmcnt(2)
    s_waitcnt vmcnt(19)
    v_mfma_f32_32x32x16_bf16 v[64:79], v[176:179], v[240:243], v[64:79]
    v_mfma_f32_32x32x16_bf16 v[80:95], v[180:183], v[240:243], v[80:95]
    s_waitcnt vmcnt(18)
    v_mfma_f32_32x32x16_bf16 v[96:111], v[176:179], v[244:247], v[96:111]
    v_mfma_f32_32x32x16_bf16 v[112:127], v[180:183], v[244:247], v[112:127]
    ds_read_b128 v[184:187], v7 offset:2048
    ds_read_b128 v[188:191], v7 offset:11264
    s_waitcnt lgkmcnt(2)
    s_waitcnt vmcnt(17)
    v_mfma_f32_32x32x16_bf16 v[64:79], v[224:227], v[152:155], v[64:79]
    v_mfma_f32_32x32x16_bf16 v[80:95], v[228:231], v[152:155], v[80:95]
    s_waitcnt vmcnt(16)
    v_mfma_f32_32x32x16_bf16 v[96:111], v[224:227], v[156:159], v[96:111]
    v_mfma_f32_32x32x16_bf16 v[112:127], v[228:231], v[156:159], v[112:127]
    ds_read_b128 v[136:139], v7 offset:3072
    ds_read_b128 v[140:143], v7 offset:12288
    s_waitcnt lgkmcnt(2)
    s_waitcnt vmcnt(15)
    v_mfma_f32_32x32x16_bf16 v[64:79], v[184:187], v[248:251], v[64:79]
    v_mfma_f32_32x32x16_bf16 v[80:95], v[188:191], v[248:251], v[80:95]
    s_waitcnt vmcnt(14)
    v_mfma_f32_32x32x16_bf16 v[96:111], v[184:187], v[252:255], v[96:111]
    v_mfma_f32_32x32x16_bf16 v[112:127], v[188:191], v[252:255], v[112:127]
    ds_read_b128 v[192:195], v7 offset:4096
    ds_read_b128 v[196:199], v7 offset:13312
    s_mov_b64 exec, s[76:77]
    buffer_load_dwordx2 v[54:55], v44, s[48:51], 0 offen sc1
    s_mov_b64 exec, -1
    s_waitcnt lgkmcnt(2)
    s_waitcnt vmcnt(14)
    v_mfma_f32_32x32x16_bf16 v[64:79], v[136:139], v[160:163], v[64:79]
    v_mfma_f32_32x32x16_bf16 v[80:95], v[140:143], v[160:163], v[80:95]
    s_waitcnt vmcnt(13)
    v_mfma_f32_32x32x16_bf16 v[96:111], v[136:139], v[164:167], v[96:111]
    v_mfma_f32_32x32x16_bf16 v[112:127], v[140:143], v[164:167], v[112:127]
    ds_read_b128 v[232:235], v7 offset:5120
    ds_read_b128 v[236:239], v7 offset:14336
    s_waitcnt lgkmcnt(2)
    s_waitcnt vmcnt(12)
    v_mfma_f32_32x32x16_bf16 v[64:79], v[192:195], v[16:19], v[64:79]
    v_mfma_f32_32x32x16_bf16 v[80:95], v[196:199], v[16:19], v[80:95]
    s_waitcnt vmcnt(11)
    v_mfma_f32_32x32x16_bf16 v[96:111], v[192:195], v[20:23], v[96:111]
    v_mfma_f32_32x32x16_bf16 v[112:127], v[196:199], v[20:23], v[112:127]
    ds_read_b128 v[200:203], v7 offset:6144
    ds_read_b128 v[204:207], v7 offset:15360
    s_waitcnt lgkmcnt(2)
    s_waitcnt vmcnt(10)
    v_mfma_f32_32x32x16_bf16 v[64:79], v[232:235], v[168:171], v[64:79]
    v_mfma_f32_32x32x16_bf16 v[80:95], v[236:239], v[168:171], v[80:95]
    s_waitcnt vmcnt(9)
    v_mfma_f32_32x32x16_bf16 v[96:111], v[232:235], v[172:175], v[96:111]
    v_mfma_f32_32x32x16_bf16 v[112:127], v[236:239], v[172:175], v[112:127]
    ds_read_b128 v[144:147], v7 offset:7168
    ds_read_b128 v[148:151], v7 offset:16384
    s_waitcnt lgkmcnt(2)
    s_waitcnt vmcnt(8)
    v_mfma_f32_32x32x16_bf16 v[64:79], v[200:203], v[24:27], v[64:79]
    v_mfma_f32_32x32x16_bf16 v[80:95], v[204:207], v[24:27], v[80:95]
    s_waitcnt vmcnt(7)
    v_mfma_f32_32x32x16_bf16 v[96:111], v[200:203], v[28:31], v[96:111]
    v_mfma_f32_32x32x16_bf16 v[112:127], v[204:207], v[28:31], v[112:127]
    ds_read_b128 v[176:179], v7 offset:8192
    ds_read_b128 v[180:183], v7 offset:17408
    s_waitcnt lgkmcnt(2)
    s_waitcnt vmcnt(6)
    v_mfma_f32_32x32x16_bf16 v[64:79], v[144:147], v[216:219], v[64:79]
    v_mfma_f32_32x32x16_bf16 v[80:95], v[148:151], v[216:219], v[80:95]
    s_waitcnt vmcnt(5)
    v_mfma_f32_32x32x16_bf16 v[96:111], v[144:147], v[220:223], v[96:111]
    v_mfma_f32_32x32x16_bf16 v[112:127], v[148:151], v[220:223], v[112:127]
    s_waitcnt vmcnt(0)
    s_mov_b64 exec, s[76:77]
    v_cmp_ne_u64 vcc, s[42:43], v[54:55]
    s_mov_b64 exec, -1
    s_cbranch_vccz Pf3ok_17
    s_mov_b32 s70, 8192
Pf3sp_18:
    s_mov_b64 exec, s[76:77]
    buffer_load_dwordx2 v[54:55], v44, s[48:51], 0 offen sc1
    s_sub_u32 s70, s70, 1
    s_waitcnt vmcnt(0)
    v_cmp_ne_u64 vcc, s[42:43], v[54:55]
    s_mov_b64 exec, -1
    s_cbranch_vccz Pf3ok_17
    s_cmp_lg_u32 s70, 0
    s_cbranch_scc1 Pf3sp_18
Pf3ok_17:
    buffer_load_dwordx4 v[240:243], v45, s[48:51], 0 offen sc1
    s_mov_b32 s64, 65536
    buffer_load_dwordx4 v[244:247], v45, s[48:51], s64 offen sc1
    buffer_load_dwordx2 v[56:57], v46, s[48:51], 0 offen sc1
    s_waitcnt lgkmcnt(0)
    v_mfma_f32_32x32x16_bf16 v[64:79], v[176:179], v[32:35], v[64:79]
    v_mfma_f32_32x32x16_bf16 v[80:95], v[180:183], v[32:35], v[80:95]
    v_mfma_f32_32x32x16_bf16 v[96:111], v[176:179], v[36:39], v[96:111]
    v_mfma_f32_32x32x16_bf16 v[112:127], v[180:183], v[36:39], v[112:127]
    v_mfma_f32_32x32x16_bf16 v[64:79], v[208:211], v[128:131], v[64:79]
    v_mfma_f32_32x32x16_bf16 v[80:95], v[212:215], v[128:131], v[80:95]
    v_mfma_f32_32x32x16_bf16 v[96:111], v[208:211], v[132:135], v[96:111]
    v_mfma_f32_32x32x16_bf16 v[112:127], v[212:215], v[132:135], v[112:127]
    v_add_u32 v4, s66, v50
    v_add_u32 v5, s67, v50
    v_add_u32 v6, s68, v50
    s_nop 6
    ds_write_b128 v7, v[80:83] offset:0
    ds_write_b128 v7, v[84:87] offset:1024
    ds_write_b128 v7, v[88:91] offset:2048
    ds_write_b128 v7, v[92:95] offset:3072
    ds_write_b128 v7, v[96:99] offset:4096
    ds_write_b128 v7, v[100:103] offset:5120
    ds_write_b128 v7, v[104:107] offset:6144
    ds_write_b128 v7, v[108:111] offset:7168
    ds_write_b128 v7, v[112:115] offset:8192
    ds_write_b128 v7, v[116:119] offset:9216
    ds_write_b128 v7, v[120:123] offset:10240
    ds_write_b128 v7, v[124:127] offset:11264
    s_waitcnt vmcnt(1)
    ds_write_b128 v7, v[240:243] offset:18432
    ds_write_b128 v7, v[244:247] offset:19456
    s_waitcnt lgkmcnt(0)
    s_barrier
    ds_read_b128 v[128:131], v4 offset:0
    ds_read_b128 v[132:135], v4 offset:1024
    ds_read_b128 v[136:139], v4 offset:2048
    ds_read_b128 v[140:143], v4 offset:3072
    ds_read_b128 v[144:147], v5 offset:0
    ds_read_b128 v[148:151], v5 offset:1024
    ds_read_b128 v[152:155], v5 offset:2048
    ds_read_b128 v[156:159], v5 offset:3072
    ds_read_b128 v[160:163], v6 offset:0
    ds_read_b128 v[164:167], v6 offset:1024
    ds_read_b128 v[168:171], v6 offset:2048
    ds_read_b128 v[172:175], v6 offset:3072
    ds_read_b64_tr_b16 v[176:177], v48 offset:0
    ds_read_b64_tr_b16 v[178:179], v48 offset:512
    ds_read_b64_tr_b16 v[180:181], v48 offset:1024
    ds_read_b64_tr_b16 v[182:183], v48 offset:1536
    s_waitcnt lgkmcnt(12)
    v_pk_add_f32 v[64:65], v[64:65], v[128:129]
    v_pk_add_f32 v[66:67], v[66:67], v[130:131]
    v_pk_add_f32 v[68:69], v[68:69], v[132:133]
    v_pk_add_f32 v[70:71], v[70:71], v[134:135]
    v_pk_add_f32 v[72:73], v[72:73], v[136:137]
    v_pk_add_f32 v[74:75], v[74:75], v[138:139]
    v_pk_add_f32 v[76:77], v[76:77], v[140:141]
    v_pk_add_f32 v[78:79], v[78:79], v[142:143]
    s_waitcnt lgkmcnt(8)
    v_pk_add_f32 v[64:65], v[64:65], v[144:145]
    v_pk_add_f32 v[66:67], v[66:67], v[146:147]
    v_pk_add_f32 v[68:69], v[68:69], v[148:149]
    v_pk_add_f32 v[70:71], v[70:71], v[150:151]
    v_pk_add_f32 v[72:73], v[72:73], v[152:153]
    v_pk_add_f32 v[74:75], v[74:75], v[154:155]
    v_pk_add_f32 v[76:77], v[76:77], v[156:157]
    v_pk_add_f32 v[78:79], v[78:79], v[158:159]
    s_waitcnt lgkmcnt(4)
    v_pk_add_f32 v[64:65], v[64:65], v[160:161]
    v_pk_add_f32 v[66:67], v[66:67], v[162:163]
    v_pk_add_f32 v[68:69], v[68:69], v[164:165]
    v_pk_add_f32 v[70:71], v[70:71], v[166:167]
    v_pk_add_f32 v[72:73], v[72:73], v[168:169]
    v_pk_add_f32 v[74:75], v[74:75], v[170:171]
    v_pk_add_f32 v[76:77], v[76:77], v[172:173]
    v_pk_add_f32 v[78:79], v[78:79], v[174:175]
    s_waitcnt vmcnt(0) lgkmcnt(0)
    v_lshlrev_b32 v184, 16, v176
    v_and_b32 v185, 0xffff0000, v176
    v_lshlrev_b32 v186, 16, v177
    v_and_b32 v187, 0xffff0000, v177
    v_lshlrev_b32 v188, 16, v178
    v_and_b32 v189, 0xffff0000, v178
    v_lshlrev_b32 v190, 16, v179
    v_and_b32 v191, 0xffff0000, v179
    v_lshlrev_b32 v192, 16, v180
    v_and_b32 v193, 0xffff0000, v180
    v_lshlrev_b32 v194, 16, v181
    v_and_b32 v195, 0xffff0000, v181
    v_lshlrev_b32 v196, 16, v182
    v_and_b32 v197, 0xffff0000, v182
    v_lshlrev_b32 v198, 16, v183
    v_and_b32 v199, 0xffff0000, v183
    v_pk_mul_f32 v[184:185], v[184:185], v[56:57] op_sel:[0,0] op_sel_hi:[1,0]
    v_pk_mul_f32 v[186:187], v[186:187], v[56:57] op_sel:[0,0] op_sel_hi:[1,0]
    v_pk_mul_f32 v[188:189], v[188:189], v[56:57] op_sel:[0,0] op_sel_hi:[1,0]
    v_pk_mul_f32 v[190:191], v[190:191], v[56:57] op_sel:[0,0] op_sel_hi:[1,0]
    v_pk_mul_f32 v[192:193], v[192:193], v[56:57] op_sel:[0,0] op_sel_hi:[1,0]
    v_pk_mul_f32 v[194:195], v[194:195], v[56:57] op_sel:[0,0] op_sel_hi:[1,0]
    v_pk_mul_f32 v[196:197], v[196:197], v[56:57] op_sel:[0,0] op_sel_hi:[1,0]
    v_pk_mul_f32 v[198:199], v[198:199], v[56:57] op_sel:[0,0] op_sel_hi:[1,0]
    v_pk_fma_f32 v[184:185], v[64:65], v[56:57], v[184:185] op_sel:[0,1,0] op_sel_hi:[1,1,1]
    v_pk_fma_f32 v[186:187], v[66:67], v[56:57], v[186:187] op_sel:[0,1,0] op_sel_hi:[1,1,1]
    v_pk_fma_f32 v[188:189], v[68:69], v[56:57], v[188:189] op_sel:[0,1,0] op_sel_hi:[1,1,1]
    v_pk_fma_f32 v[190:191], v[70:71], v[56:57], v[190:191] op_sel:[0,1,0] op_sel_hi:[1,1,1]
    v_pk_fma_f32 v[192:193], v[72:73], v[56:57], v[192:193] op_sel:[0,1,0] op_sel_hi:[1,1,1]
    v_pk_fma_f32 v[194:195], v[74:75], v[56:57], v[194:195] op_sel:[0,1,0] op_sel_hi:[1,1,1]
    v_pk_fma_f32 v[196:197], v[76:77], v[56:57], v[196:197] op_sel:[0,1,0] op_sel_hi:[1,1,1]
    v_pk_fma_f32 v[198:199], v[78:79], v[56:57], v[198:199] op_sel:[0,1,0] op_sel_hi:[1,1,1]
    v_cvt_pk_bf16_f32 v200, v184, v185
    v_cvt_pk_bf16_f32 v201, v186, v187
    v_cvt_pk_bf16_f32 v202, v188, v189
    v_cvt_pk_bf16_f32 v203, v190, v191
    v_cvt_pk_bf16_f32 v204, v192, v193
    v_cvt_pk_bf16_f32 v205, v194, v195
    v_cvt_pk_bf16_f32 v206, v196, v197
    v_cvt_pk_bf16_f32 v207, v198, v199
    v_permlane32_swap_b32 v200, v202
    v_permlane32_swap_b32 v201, v203
    buffer_store_dwordx4 v[200:203], v49, s[52:55], 0 offen offset:0
    v_permlane32_swap_b32 v204, v206
    v_permlane32_swap_b32 v205, v207
    buffer_store_dwordx4 v[204:207], v49, s[52:55], 0 offen offset:32
    s_endpgm
L_q:
    s_load_dwordx16 s[4:19], s[0:1], 0
    s_load_dwordx2 s[20:21], s[0:1], 64
    s_load_dwordx4 s[24:27], s[0:1], 96
    s_load_dwordx4 s[40:43], s[0:1], 120
    s_load_dwordx4 s[52:55], s[0:1], 80
    s_and_b32 s3, s2, 255
    s_and_b32 s56, s3, 7
    s_lshl_b32 s56, s56, 5
    s_lshr_b32 s3, s3, 3
    s_or_b32 s3, s3, s56
    v_lshrrev_b32 v22, 6, v0
    v_and_b32 v1, 63, v0
    s_lshl_b32 s56, s3, 9
    v_readfirstlane_b32 s28, v22
    v_lshlrev_b32 v23, 1, v0
    v_add_u32 v23, s56, v23
    v_lshrrev_b32 v24, 7, v0
    v_lshlrev_b32 v24, 1, v24
    s_lshl_b32 s56, s3, 2
    v_add_u32 v24, s56, v24
    s_and_b32 s29, s28, 1
    s_lshl_b32 s56, s3, 3
    s_lshl_b32 s57, s28, 1
    s_add_u32 s30, s56, s57
    s_lshl_b32 s56, s30, 10
    v_lshlrev_b32 v25, 4, v1
    v_add_u32 v26, s56, v25
    s_lshr_b32 s58, s3, 4
    s_and_b32 s59, s3, 15
    s_lshl_b32 s56, s58, 7
    s_add_u32 s56, s56, s28
    s_lshl_b32 s56, s56, 10
    s_lshl_b32 s57, s59, 6
    s_add_u32 s56, s56, s57
    v_lshrrev_b32 v27, 2, v1
    v_lshlrev_b32 v27, 12, v27
    v_and_b32 v28, 3, v1
    v_lshlrev_b32 v28, 4, v28
    v_add3_u32 v27, v27, v28, s56
    s_lshl_b32 s56, s3, 2
    s_add_u32 s56, s56, s28
    s_lshr_b32 s60, s56, 3
    s_and_b32 s61, s56, 7
    s_lshl_b32 s56, s60, 14
    s_lshl_b32 s57, s61, 7
    s_add_u32 s56, s56, s57
    v_lshrrev_b32 v28, 3, v1
    v_lshlrev_b32 v28, 10, v28
    v_and_b32 v29, 7, v1
    v_lshlrev_b32 v29, 4, v29
    v_add3_u32 v28, v28, v29, s56
    s_lshl_b32 s62, s28, 11
    s_waitcnt lgkmcnt(0)
    global_load_ushort v2, v23, s[6:7]
    global_load_ushort v3, v23, s[8:9]
    global_load_ushort v4, v23, s[10:11]
    global_load_ushort v5, v23, s[12:13]
    global_load_ushort v6, v23, s[14:15]
    global_load_ushort v7, v23, s[16:17]
    global_load_ushort v8, v24, s[18:19]
    global_load_ushort v9, v24, s[20:21]
    s_mov_b32 s32, s4
    s_mov_b32 s33, s5
    s_mov_b32 s34, 2097152
    s_mov_b32 s35, 0x00020000
    s_mov_b32 s36, s24
    s_mov_b32 s37, s25
    s_mov_b32 s38, 1409024
    s_mov_b32 s39, 0x00020000
    s_add_u32 m0, s62, 65536
    s_mov_b32 s56, 65536
    buffer_load_dwordx4 v27, s[32:35], 0 offen lds
    s_add_u32 m0, s62, 66560
    s_nop 0
    buffer_load_dwordx4 v27, s[32:35], s56 offen lds
    s_add_u32 m0, s62, 73728
    s_mov_b32 s56, 8192
    buffer_load_dwordx4 v28, s[36:39], 0 offen lds
    s_add_u32 m0, s62, 74752
    s_nop 0
    buffer_load_dwordx4 v28, s[36:39], s56 offen lds
    global_load_dwordx4 v[240:243], v26, s[4:5]
    global_load_dwordx4 v[244:247], v26, s[4:5] offset:1024
    global_load_dwordx4 v[248:251], v25, s[26:27]
    s_mov_b32 s48, s42
    s_mov_b32 s49, s43
    s_mov_b32 s50, 14680064
    s_mov_b32 s51, 0x00020000
    v_lshrrev_b32 v10, 4, v1
    v_lshlrev_b32 v11, 3, v10
    v_bfe_u32 v12, v1, 2, 2
    v_add_u32 v11, v11, v12
    v_sub_u32 v11, 27, v11
    v_lshlrev_b32 v11, 6, v11
    v_and_b32 v13, 3, v1
    v_lshlrev_b32 v13, 3, v13
    s_add_u32 s56, s62, 65536
    v_add3_u32 v14, v11, v13, s56
    v_lshrrev_b32 v11, 5, v1
    v_lshlrev_b32 v11, 3, v11
    v_add_u32 v11, v11, v12
    v_lshlrev_b32 v11, 7, v11
    v_and_b32 v15, 1, v10
    v_lshlrev_b32 v15, 5, v15
    v_add3_u32 v11, v11, v15, v13
    s_add_u32 s56, s62, 73728
    v_add_u32 v15, s56, v11
    s_lshl_b32 s56, s58, 2
    s_add_u32 s56, s56, s28
    s_lshl_b32 s56, s56, 9
    s_lshl_b32 s57, s59, 5
    s_add_u32 s56, s56, s57
    s_lshl_b32 s56, s56, 6
    s_add_u32 s56, s56, 6291456
    v_and_b32 v16, 15, v1
    v_lshlrev_b32 v16, 6, v16
    v_lshlrev_b32 v17, 4, v10
    v_add3_u32 v16, v16, v17, s56
    s_mul_i32 s56, s61, 172
    s_add_u32 s56, s56, s60
    s_lshl_b32 s56, s56, 10
    s_add_u32 s56, s56, 10485760
    s_cmp_ge_u32 s60, 86
    s_cselect_b32 s64, 0x10000000, s56
    s_add_u32 s65, s64, 88064
    s_lshl_b32 s56, s3, 7
    s_lshl_b32 s57, s28, 3
    s_add_u32 s56, s56, s57
    s_add_u32 s56, s56, 5963776
    v_mov_b32 v17, s56
    s_lshr_b32 s56, s3, 4
    s_lshl_b32 s56, s56, 7
    s_add_u32 s56, s56, 5963776
    v_lshrrev_b32 v18, 2, v1
    v_lshlrev_b32 v18, 11, v18
    v_and_b32 v19, 3, v1
    v_lshlrev_b32 v19, 3, v19
    v_add3_u32 v18, v18, v19, s56
    v_mov_b32 v19, 0
    s_mov_b64 s[66:67], -1
    s_lshr_b32 s31, s28, 1
    s_lshl_b32 s47, s3, 1
    s_add_u32 s47, s47, s31
    v_lshrrev_b32 v20, 2, v1
    v_sub_u32 v20, 15, v20
    v_lshlrev_b32 v20, 17, v20
    v_and_b32 v21, 3, v1
    v_lshlrev_b32 v21, 4, v21
    s_lshl_b32 s56, s29, 16
    s_lshl_b32 s57, s47, 6
    s_add_u32 s56, s56, s57
    s_add_u32 s56, s56, 6291456
    v_add3_u32 v20, v20, v21, s56
    v_and_b32 v30, 127, v0
    v_lshlrev_b32 v30, 4, v30
    v_lshrrev_b32 v31, 7, v0
    v_lshlrev_b32 v31, 15, v31
    v_add_u32 v30, v30, v31
    v_xor_b32 v31, 64, v30
    s_setprio 3
    s_waitcnt vmcnt(7)
    s_waitcnt vmcnt(3)
    ds_read_b64_tr_b16 v[224:225], v14 offset:256
    ds_read_b64_tr_b16 v[226:227], v14 offset:0
    ds_read_b64_tr_b16 v[228:229], v14 offset:288
    ds_read_b64_tr_b16 v[230:231], v14 offset:32
    ds_read_b64_tr_b16 v[232:233], v15 offset:0
    ds_read_b64_tr_b16 v[234:235], v15 offset:512
    ds_read_b64_tr_b16 v[236:237], v15 offset:64
    ds_read_b64_tr_b16 v[238:239], v15 offset:576
    v_lshlrev_b32 v8, 16, v8
    s_mov_b32 s56, 1069066811
    s_mov_b32 s57, 849703008
    s_mov_b32 s63, 1060205080
    v_mul_f32 v186, s56, v8
    v_exp_f32 v187, v186
    v_fma_f32 v188, v8, s56, -v186
    v_fma_f32 v188, v8, s57, v188
    v_mul_f32 v188, s63, v188
    v_fma_f32 v187, v187, v188, v187
    v_lshlrev_b32 v2, 16, v2
    v_lshlrev_b32 v3, 16, v3
    v_lshlrev_b32 v4, 16, v4
    v_lshlrev_b32 v5, 16, v5
    v_lshlrev_b32 v6, 16, v6
    v_lshlrev_b32 v7, 16, v7
    v_cvt_pk_bf16_f32 v22, 0, v187
    v_lshlrev_b32 v9, 16, v9
    v_mul_f32 v2, v22, v2
    v_mul_f32 v3, v22, v3
    v_mul_f32 v4, v22, v4
    v_mul_f32 v5, v22, v5
    v_mul_f32 v23, s56, v2
    v_mul_f32 v24, 0.15915494, v3
    s_waitcnt lgkmcnt(4)
    buffer_store_dwordx4 v[224:227], v16, s[48:51], 0 offen sc1
    buffer_store_dwordx4 v[228:231], v16, s[48:51], 0 offen offset:1024 sc1
    s_waitcnt lgkmcnt(0)
    buffer_store_dwordx4 v[232:235], v25, s[48:51], s64 offen sc1
    buffer_store_dwordx4 v[236:239], v25, s[48:51], s65 offen sc1
    global_load_dwordx2 v[252:253], v19, s[40:41] sc1
    v_mul_f32 v186, 4.0, v23
    v_mul_f32 v187, 4.0, v24
    v_exp_f32 v186, v186
    v_fract_f32 v187, v187
    v_mul_f32 v188, 0x42800000, v23
    v_mul_f32 v189, 0x42800000, v24
    v_exp_f32 v188, v188
    v_fract_f32 v189, v189
    v_exp_f32 v190, v23
    v_fract_f32 v191, v24
    v_mul_f32 v26, 0x44000000, v23
    v_mul_f32 v27, 0x44000000, v24
    v_exp_f32 v26, v26
    v_fract_f32 v27, v27
    v_mul_f32 v178, v7, v5
    v_mul_f32 v179, v7, v4
    v_fma_f32 v64, v6, v4, -v178
    v_fma_f32 v65, v6, v5, v179
    v_cos_f32 v34, v187
    v_sin_f32 v35, v187
    v_cos_f32 v164, v189
    v_sin_f32 v165, v189
    v_cos_f32 v162, v191
    v_sin_f32 v163, v191
    v_cos_f32 v166, v27
    v_sin_f32 v167, v27
    s_nop 0
    v_mul_f32 v34, v186, v34
    v_mul_f32 v35, v186, v35
    v_mul_f32 v164, v188, v164
    v_mul_f32 v165, v188, v165
    v_mul_f32 v162, v190, v162
    v_mul_f32 v163, v190, v163
    v_mul_f32 v166, v26, v166
    v_mul_f32 v167, v26, v167
    v_mov_b32 v32, 1.0
    v_mov_b32 v33, 0
    v_mul_f32 v180, v35, v35
    v_mul_f32 v181, v35, v34
    v_fma_f32 v36, v34, v34, -v180
    v_fma_f32 v37, v34, v35, v181
    v_mul_f32 v182, v165, v165
    v_mul_f32 v183, v165, v164
    v_fma_f32 v168, v164, v164, -v182
    v_fma_f32 v169, v164, v165, v183
    v_mul_f32 v184, v37, v35
    v_mul_f32 v185, v37, v34
    v_fma_f32 v38, v36, v34, -v184
    v_fma_f32 v39, v36, v35, v185
    v_mul_f32 v178, v163, v163
    v_mul_f32 v179, v163, v162
    v_fma_f32 v174, v162, v162, -v178
    v_fma_f32 v175, v162, v163, v179
    v_mul_f32 v180, v37, v37
    v_mul_f32 v181, v37, v36
    v_fma_f32 v40, v36, v36, -v180
    v_fma_f32 v41, v36, v37, v181
    v_mul_f32 v182, v169, v165
    v_mul_f32 v183, v169, v164
    v_fma_f32 v170, v168, v164, -v182
    v_fma_f32 v171, v168, v165, v183
    v_mul_f32 v184, v169, v169
    v_mul_f32 v185, v169, v168
    v_fma_f32 v172, v168, v168, -v184
    v_fma_f32 v173, v168, v169, v185
    v_mul_f32 v178, v175, v163
    v_mul_f32 v179, v175, v162
    v_fma_f32 v176, v174, v162, -v178
    v_fma_f32 v177, v174, v163, v179
    s_waitcnt vmcnt(0)
    v_readfirstlane_b32 s44, v252
    v_readfirstlane_b32 s45, v253
    s_cmp_lg_u32 s44, 0
    s_cbranch_scc1 Qnok_5001
    s_mov_b32 s46, 8192
Qnsp_5002:
    global_load_dwordx2 v[252:253], v19, s[40:41] sc1
    s_sub_u32 s46, s46, 1
    s_waitcnt vmcnt(0)
    v_readfirstlane_b32 s44, v252
    v_readfirstlane_b32 s45, v253
    s_cmp_lg_u32 s44, 0
    s_cbranch_scc1 Qnok_5001
    s_cmp_lg_u32 s46, 0
    s_cbranch_scc1 Qnsp_5002
Qnok_5001:
    v_mov_b32 v252, s44
    v_mov_b32 v253, s45
    s_mov_b64 exec, 1
    buffer_store_dwordx2 v[252:253], v17, s[48:51], 0 offen sc1
    s_mov_b64 exec, -1
    s_setprio 0
    v_mul_f32 v180, v41, v35
    v_mul_f32 v181, v41, v34
    v_fma_f32 v42, v40, v34, -v180
    v_fma_f32 v43, v40, v35, v181
    v_mul_f32 v182, v41, v37
    v_mul_f32 v183, v41, v36
    v_fma_f32 v44, v40, v36, -v182
    v_fma_f32 v45, v40, v37, v183
    v_mul_f32 v184, v41, v39
    v_mul_f32 v185, v41, v38
    v_fma_f32 v46, v40, v38, -v184
    v_fma_f32 v47, v40, v39, v185
    v_mul_f32 v178, v41, v41
    v_mul_f32 v179, v41, v40
    v_fma_f32 v48, v40, v40, -v178
    v_fma_f32 v49, v40, v41, v179
    v_cvt_pk_bf16_f32 v192, v32, v34
    v_cvt_pk_bf16_f32 v193, v36, v38
    v_cvt_pk_bf16_f32 v194, v40, v42
    v_cvt_pk_bf16_f32 v195, v44, v46
    ds_write_b128 v30, v[192:195] offset:0
    v_cvt_pk_bf16_f32 v196, -v33, -v35
    v_cvt_pk_bf16_f32 v197, -v37, -v39
    v_cvt_pk_bf16_f32 v198, -v41, -v43
    v_cvt_pk_bf16_f32 v199, -v45, -v47
    ds_write_b128 v30, v[196:199] offset:2048
    v_mul_f32 v180, v49, v35
    v_mul_f32 v181, v49, v34
    v_fma_f32 v50, v48, v34, -v180
    v_fma_f32 v51, v48, v35, v181
    v_mul_f32 v182, v49, v37
    v_mul_f32 v183, v49, v36
    v_fma_f32 v52, v48, v36, -v182
    v_fma_f32 v53, v48, v37, v183
    v_mul_f32 v184, v49, v39
    v_mul_f32 v185, v49, v38
    v_fma_f32 v54, v48, v38, -v184
    v_fma_f32 v55, v48, v39, v185
    v_mul_f32 v178, v49, v41
    v_mul_f32 v179, v49, v40
    v_fma_f32 v56, v48, v40, -v178
    v_fma_f32 v57, v48, v41, v179
    v_mul_f32 v180, v49, v43
    v_mul_f32 v181, v49, v42
    v_fma_f32 v58, v48, v42, -v180
    v_fma_f32 v59, v48, v43, v181
    v_mul_f32 v182, v49, v45
    v_mul_f32 v183, v49, v44
    v_fma_f32 v60, v48, v44, -v182
    v_fma_f32 v61, v48, v45, v183
    v_mul_f32 v184, v49, v47
    v_mul_f32 v185, v49, v46
    v_fma_f32 v62, v48, v46, -v184
    v_fma_f32 v63, v48, v47, v185
    v_cvt_pk_bf16_f32 v200, v48, v50
    v_cvt_pk_bf16_f32 v201, v52, v54
    v_cvt_pk_bf16_f32 v202, v56, v58
    v_cvt_pk_bf16_f32 v203, v60, v62
    ds_write_b128 v31, v[200:203] offset:4096
    v_cvt_pk_bf16_f32 v204, -v49, -v51
    v_cvt_pk_bf16_f32 v205, -v53, -v55
    v_cvt_pk_bf16_f32 v206, -v57, -v59
    v_cvt_pk_bf16_f32 v207, -v61, -v63
    ds_write_b128 v31, v[204:207] offset:6144
    v_mul_f32 v178, v65, v163
    v_mul_f32 v179, v65, v162
    v_fma_f32 v72, v64, v162, -v178
    v_fma_f32 v73, v64, v163, v179
    v_mul_f32 v180, v65, v175
    v_mul_f32 v181, v65, v174
    v_fma_f32 v80, v64, v174, -v180
    v_fma_f32 v81, v64, v175, v181
    v_mul_f32 v182, v65, v177
    v_mul_f32 v183, v65, v176
    v_fma_f32 v88, v64, v176, -v182
    v_fma_f32 v89, v64, v177, v183
    v_mul_f32 v184, v65, v167
    v_mul_f32 v185, v65, v166
    v_fma_f32 v112, v64, v166, -v184
    v_fma_f32 v113, v64, v167, v185
    v_mul_f32 v178, v65, v165
    v_mul_f32 v179, v65, v164
    v_fma_f32 v66, v64, v164, -v178
    v_fma_f32 v67, v64, v165, v179
    v_mul_f32 v180, v65, v169
    v_mul_f32 v181, v65, v168
    v_fma_f32 v68, v64, v168, -v180
    v_fma_f32 v69, v64, v169, v181
    v_mul_f32 v182, v65, v171
    v_mul_f32 v183, v65, v170
    v_fma_f32 v70, v64, v170, -v182
    v_fma_f32 v71, v64, v171, v183
    v_mul_f32 v184, v113, v165
    v_mul_f32 v185, v113, v164
    v_fma_f32 v114, v112, v164, -v184
    v_fma_f32 v115, v112, v165, v185
    v_mul_f32 v178, v73, v165
    v_mul_f32 v179, v73, v164
    v_fma_f32 v74, v72, v164, -v178
    v_fma_f32 v75, v72, v165, v179
    v_mul_f32 v180, v73, v169
    v_mul_f32 v181, v73, v168
    v_fma_f32 v76, v72, v168, -v180
    v_fma_f32 v77, v72, v169, v181
    v_mul_f32 v182, v73, v171
    v_mul_f32 v183, v73, v170
    v_fma_f32 v78, v72, v170, -v182
    v_fma_f32 v79, v72, v171, v183
    v_mul_f32 v184, v115, v165
    v_mul_f32 v185, v115, v164
    v_fma_f32 v116, v114, v164, -v184
    v_fma_f32 v117, v114, v165, v185
    v_cvt_pk_bf16_f32 v208, v64, v66
    v_cvt_pk_bf16_f32 v209, v68, v70
    v_cvt_pk_bf16_f32 v210, v72, v74
    v_cvt_pk_bf16_f32 v211, v76, v78
    ds_write_b128 v30, v[208:211] offset:8192
    v_cvt_pk_bf16_f32 v212, v65, v67
    v_cvt_pk_bf16_f32 v213, v69, v71
    v_cvt_pk_bf16_f32 v214, v73, v75
    v_cvt_pk_bf16_f32 v215, v77, v79
    ds_write_b128 v30, v[212:215] offset:10240
    v_mul_f32 v178, v81, v165
    v_mul_f32 v179, v81, v164
    v_fma_f32 v82, v80, v164, -v178
    v_fma_f32 v83, v80, v165, v179
    v_mul_f32 v180, v81, v169
    v_mul_f32 v181, v81, v168
    v_fma_f32 v84, v80, v168, -v180
    v_fma_f32 v85, v80, v169, v181
    v_mul_f32 v182, v81, v171
    v_mul_f32 v183, v81, v170
    v_fma_f32 v86, v80, v170, -v182
    v_fma_f32 v87, v80, v171, v183
    v_mul_f32 v184, v117, v165
    v_mul_f32 v185, v117, v164
    v_fma_f32 v118, v116, v164, -v184
    v_fma_f32 v119, v116, v165, v185
    v_mul_f32 v178, v89, v165
    v_mul_f32 v179, v89, v164
    v_fma_f32 v90, v88, v164, -v178
    v_fma_f32 v91, v88, v165, v179
    v_mul_f32 v180, v89, v169
    v_mul_f32 v181, v89, v168
    v_fma_f32 v92, v88, v168, -v180
    v_fma_f32 v93, v88, v169, v181
    v_mul_f32 v182, v89, v171
    v_mul_f32 v183, v89, v170
    v_fma_f32 v94, v88, v170, -v182
    v_fma_f32 v95, v88, v171, v183
    v_cvt_pk_bf16_f32 v216, v80, v82
    v_cvt_pk_bf16_f32 v217, v84, v86
    v_cvt_pk_bf16_f32 v218, v88, v90
    v_cvt_pk_bf16_f32 v219, v92, v94
    ds_write_b128 v31, v[216:219] offset:12288
    v_cvt_pk_bf16_f32 v220, v81, v83
    v_cvt_pk_bf16_f32 v221, v85, v87
    v_cvt_pk_bf16_f32 v222, v89, v91
    v_cvt_pk_bf16_f32 v223, v93, v95
    ds_write_b128 v31, v[220:223] offset:14336
    v_mul_f32 v184, v81, v173
    v_mul_f32 v185, v81, v172
    v_fma_f32 v96, v80, v172, -v184
    v_fma_f32 v97, v80, v173, v185
    v_mul_f32 v178, v119, v165
    v_mul_f32 v179, v119, v164
    v_fma_f32 v120, v118, v164, -v178
    v_fma_f32 v121, v118, v165, v179
    v_mul_f32 v180, v83, v173
    v_mul_f32 v181, v83, v172
    v_fma_f32 v98, v82, v172, -v180
    v_fma_f32 v99, v82, v173, v181
    v_mul_f32 v182, v121, v165
    v_mul_f32 v183, v121, v164
    v_fma_f32 v122, v120, v164, -v182
    v_fma_f32 v123, v120, v165, v183
    v_mul_f32 v184, v85, v173
    v_mul_f32 v185, v85, v172
    v_fma_f32 v100, v84, v172, -v184
    v_fma_f32 v101, v84, v173, v185
    v_mul_f32 v178, v123, v165
    v_mul_f32 v179, v123, v164
    v_fma_f32 v124, v122, v164, -v178
    v_fma_f32 v125, v122, v165, v179
    v_mul_f32 v180, v87, v173
    v_mul_f32 v181, v87, v172
    v_fma_f32 v102, v86, v172, -v180
    v_fma_f32 v103, v86, v173, v181
    v_mul_f32 v182, v125, v165
    v_mul_f32 v183, v125, v164
    v_fma_f32 v126, v124, v164, -v182
    v_fma_f32 v127, v124, v165, v183
    v_mul_f32 v184, v65, v173
    v_mul_f32 v185, v65, v172
    v_fma_f32 v104, v64, v172, -v184
    v_fma_f32 v105, v64, v173, v185
    v_mul_f32 v178, v67, v173
    v_mul_f32 v179, v67, v172
    v_fma_f32 v106, v66, v172, -v178
    v_fma_f32 v107, v66, v173, v179
    v_mul_f32 v180, v69, v173
    v_mul_f32 v181, v69, v172
    v_fma_f32 v108, v68, v172, -v180
    v_fma_f32 v109, v68, v173, v181
    v_mul_f32 v182, v71, v173
    v_mul_f32 v183, v71, v172
    v_fma_f32 v110, v70, v172, -v182
    v_fma_f32 v111, v70, v173, v183
    s_waitcnt lgkmcnt(6)
    v_cvt_pk_bf16_f32 v192, v96, v98
    v_cvt_pk_bf16_f32 v193, v100, v102
    v_cvt_pk_bf16_f32 v194, v104, v106
    v_cvt_pk_bf16_f32 v195, v108, v110
    ds_write_b128 v30, v[192:195] offset:16384
    v_cvt_pk_bf16_f32 v196, v97, v99
    v_cvt_pk_bf16_f32 v197, v101, v103
    v_cvt_pk_bf16_f32 v198, v105, v107
    v_cvt_pk_bf16_f32 v199, v109, v111
    ds_write_b128 v30, v[196:199] offset:18432
    s_waitcnt lgkmcnt(6)
    v_cvt_pk_bf16_f32 v200, v112, v114
    v_cvt_pk_bf16_f32 v201, v116, v118
    v_cvt_pk_bf16_f32 v202, v120, v122
    v_cvt_pk_bf16_f32 v203, v124, v126
    ds_write_b128 v31, v[200:203] offset:20480
    v_cvt_pk_bf16_f32 v204, v113, v115
    v_cvt_pk_bf16_f32 v205, v117, v119
    v_cvt_pk_bf16_f32 v206, v121, v123
    v_cvt_pk_bf16_f32 v207, v125, v127
    ds_write_b128 v31, v[204:207] offset:22528
    v_mul_f32 v184, v127, v165
    v_mul_f32 v185, v127, v164
    v_fma_f32 v128, v126, v164, -v184
    v_fma_f32 v129, v126, v165, v185
    v_mul_f32 v178, v127, v169
    v_mul_f32 v179, v127, v168
    v_fma_f32 v130, v126, v168, -v178
    v_fma_f32 v131, v126, v169, v179
    v_mul_f32 v180, v129, v169
    v_mul_f32 v181, v129, v168
    v_fma_f32 v132, v128, v168, -v180
    v_fma_f32 v133, v128, v169, v181
    v_mul_f32 v182, v131, v169
    v_mul_f32 v183, v131, v168
    v_fma_f32 v134, v130, v168, -v182
    v_fma_f32 v135, v130, v169, v183
    v_mul_f32 v184, v133, v169
    v_mul_f32 v185, v133, v168
    v_fma_f32 v136, v132, v168, -v184
    v_fma_f32 v137, v132, v169, v185
    v_mul_f32 v178, v135, v169
    v_mul_f32 v179, v135, v168
    v_fma_f32 v138, v134, v168, -v178
    v_fma_f32 v139, v134, v169, v179
    v_mul_f32 v180, v137, v169
    v_mul_f32 v181, v137, v168
    v_fma_f32 v140, v136, v168, -v180
    v_fma_f32 v141, v136, v169, v181
    v_mul_f32 v182, v139, v169
    v_mul_f32 v183, v139, v168
    v_fma_f32 v142, v138, v168, -v182
    v_fma_f32 v143, v138, v169, v183
    s_waitcnt lgkmcnt(6)
    v_cvt_pk_bf16_f32 v208, v128, v130
    v_cvt_pk_bf16_f32 v209, v132, v134
    v_cvt_pk_bf16_f32 v210, v136, v138
    v_cvt_pk_bf16_f32 v211, v140, v142
    ds_write_b128 v30, v[208:211] offset:24576
    v_cvt_pk_bf16_f32 v212, v129, v131
    v_cvt_pk_bf16_f32 v213, v133, v135
    v_cvt_pk_bf16_f32 v214, v137, v139
    v_cvt_pk_bf16_f32 v215, v141, v143
    ds_write_b128 v30, v[212:215] offset:26624
    v_mul_f32 v184, v141, v169
    v_mul_f32 v185, v141, v168
    v_fma_f32 v144, v140, v168, -v184
    v_fma_f32 v145, v140, v169, v185
    v_mul_f32 v178, v143, v169
    v_mul_f32 v179, v143, v168
    v_fma_f32 v146, v142, v168, -v178
    v_fma_f32 v147, v142, v169, v179
    v_mul_f32 v180, v145, v169
    v_mul_f32 v181, v145, v168
    v_fma_f32 v148, v144, v168, -v180
    v_fma_f32 v149, v144, v169, v181
    v_mul_f32 v182, v147, v169
    v_mul_f32 v183, v147, v168
    v_fma_f32 v150, v146, v168, -v182
    v_fma_f32 v151, v146, v169, v183
    v_mul_f32 v184, v149, v169
    v_mul_f32 v185, v149, v168
    v_fma_f32 v152, v148, v168, -v184
    v_fma_f32 v153, v148, v169, v185
    v_mul_f32 v178, v151, v169
    v_mul_f32 v179, v151, v168
    v_fma_f32 v154, v150, v168, -v178
    v_fma_f32 v155, v150, v169, v179
    v_mul_f32 v180, v153, v169
    v_mul_f32 v181, v153, v168
    v_fma_f32 v156, v152, v168, -v180
    v_fma_f32 v157, v152, v169, v181
    v_mul_f32 v182, v155, v169
    v_mul_f32 v183, v155, v168
    v_fma_f32 v158, v154, v168, -v182
    v_fma_f32 v159, v154, v169, v183
    s_waitcnt lgkmcnt(6)
    v_cvt_pk_bf16_f32 v216, v144, v146
    v_cvt_pk_bf16_f32 v217, v148, v150
    v_cvt_pk_bf16_f32 v218, v152, v154
    v_cvt_pk_bf16_f32 v219, v156, v158
    ds_write_b128 v31, v[216:219] offset:28672
    v_cvt_pk_bf16_f32 v220, v145, v147
    v_cvt_pk_bf16_f32 v221, v149, v151
    v_cvt_pk_bf16_f32 v222, v153, v155
    v_cvt_pk_bf16_f32 v223, v157, v159
    ds_write_b128 v31, v[220:223] offset:30720
    v_mul_f32 v184, v157, v169
    v_mul_f32 v185, v157, v168
    v_fma_f32 v160, v156, v168, -v184
    v_fma_f32 v161, v156, v169, v185
    buffer_load_dwordx2 v[254:255], v18, s[48:51], 0 offen sc1
    s_nop 1
    v_add_f32_dpp v160, v160, v160 row_shr:1 row_mask:0xf bank_mask:0xf bound_ctrl:1
    s_nop 1
    v_add_f32_dpp v160, v160, v160 row_shr:2 row_mask:0xf bank_mask:0xf bound_ctrl:1
    s_nop 1
    v_add_f32_dpp v160, v160, v160 row_shr:4 row_mask:0xf bank_mask:0xf bound_ctrl:1
    s_nop 1
    v_add_f32_dpp v160, v160, v160 row_shr:8 row_mask:0xf bank_mask:0xf bound_ctrl:1
    s_nop 1
    v_add_f32_dpp v160, v160, v160 row_bcast:15 row_mask:0xa bank_mask:0xf
    s_nop 1
    v_add_f32_dpp v160, v160, v160 row_bcast:31 row_mask:0xc bank_mask:0xf
    s_nop 0
    v_readlane_b32 s68, v160, 63
    s_add_u32 s56, s62, 73728
    v_mov_b32 v3, s56
    v_mov_b32 v4, s68
    ds_write_b32 v3, v4
    v_lshrrev_b32 v2, 4, v1
    v_lshlrev_b32 v3, 3, v2
    v_bfe_u32 v4, v1, 2, 2
    v_add_u32 v3, v3, v4
    v_lshlrev_b32 v3, 4, v3
    v_bfe_u32 v5, v1, 1, 1
    v_lshlrev_b32 v6, 6, v5
    v_xor_b32 v3, v3, v6
    v_lshlrev_b32 v5, 12, v5
    v_and_b32 v6, 1, v1
    v_lshlrev_b32 v6, 3, v6
    v_add3_u32 v3, v3, v5, v6
    s_lshr_b32 s56, s28, 1
    s_lshl_b32 s57, s56, 15
    v_add_u32 v10, s57, v3
    v_xor_b32 v11, 64, v10
    s_cmp_eq_u32 s29, 0
    s_mov_b32 s69, 24576
    s_cselect_b32 s71, 8192, s69
    s_cselect_b32 s70, 16384, s69
    v_add_u32 v12, s71, v10
    v_add_u32 v13, s71, v11
    v_add_u32 v14, s70, v10
    v_add_u32 v15, s70, v11
    v_mov_b32 v29, v18
    s_lshl_b32 s68, s56, 12
    s_add_u32 s68, s68, 65536
    v_and_b32 v16, 15, v1
    v_lshlrev_b32 v17, 3, v2
    v_lshlrev_b32 v18, 5, v16
    v_add3_u32 v18, v18, v17, s68
    v_bfe_u32 v19, v1, 2, 2
    v_lshlrev_b32 v19, 7, v19
    v_and_b32 v21, 3, v1
    v_lshlrev_b32 v21, 5, v21
    v_add3_u32 v19, v19, v21, v17
    v_add_u32 v19, s68, v19
    v_add_u32 v21, 1024, v18
    s_cmp_eq_u32 s29, 0
    s_cselect_b64 vcc, -1, 0
    v_cndmask_b32 v16, v21, v19, vcc
    v_add_u32 v17, 512, v18
    v_cndmask_b32 v17, v21, v17, vcc
    v_mov_b32 v28, v20
    v_cmp_eq_u32 vcc, 0, v1
    s_cmp_eq_u32 s29, 0
    s_cselect_b64 s[70:71], vcc, 0
    v_mov_b32 v21, 0
    v_mov_b32 v22, 0
    v_mov_b32 v23, 0
    v_cndmask_b32 v20, 0, v9, s[70:71]
    s_lshr_b32 s56, s28, 1
    s_lshl_b32 s56, s56, 12
    s_add_u32 s56, s56, 73728
    v_mov_b32 v24, s56
    s_waitcnt lgkmcnt(0)
    s_barrier
    ds_read_b32 v25, v24
    ds_read_b32 v26, v24 offset:2048
    ds_read_b64_tr_b16 v[32:33], v10 offset:0
    ds_read_b64_tr_b16 v[34:35], v11 offset:0
    ds_read_b64_tr_b16 v[64:65], v12 offset:0
    ds_read_b64_tr_b16 v[66:67], v13 offset:0
    ds_read_b64_tr_b16 v[96:97], v14 offset:0
    ds_read_b64_tr_b16 v[98:99], v15 offset:0
    ds_read_b64_tr_b16 v[36:37], v10 offset:512
    ds_read_b64_tr_b16 v[38:39], v11 offset:512
    ds_read_b64_tr_b16 v[68:69], v12 offset:512
    ds_read_b64_tr_b16 v[70:71], v13 offset:512
    ds_read_b64_tr_b16 v[100:101], v14 offset:512
    ds_read_b64_tr_b16 v[102:103], v15 offset:512
    ds_read_b64_tr_b16 v[40:41], v10 offset:1024
    ds_read_b64_tr_b16 v[42:43], v11 offset:1024
    ds_read_b64_tr_b16 v[72:73], v12 offset:1024
    ds_read_b64_tr_b16 v[74:75], v13 offset:1024
    ds_read_b64_tr_b16 v[104:105], v14 offset:1024
    ds_read_b64_tr_b16 v[106:107], v15 offset:1024
    ds_read_b64_tr_b16 v[44:45], v10 offset:1536
    ds_read_b64_tr_b16 v[46:47], v11 offset:1536
    ds_read_b64_tr_b16 v[76:77], v12 offset:1536
    ds_read_b64_tr_b16 v[78:79], v13 offset:1536
    ds_read_b64_tr_b16 v[108:109], v14 offset:1536
    ds_read_b64_tr_b16 v[110:111], v15 offset:1536
    ds_read_b64_tr_b16 v[48:49], v10 offset:2048
    ds_read_b64_tr_b16 v[50:51], v11 offset:2048
    ds_read_b64_tr_b16 v[80:81], v12 offset:2048
    ds_read_b64_tr_b16 v[82:83], v13 offset:2048
    ds_read_b64_tr_b16 v[112:113], v14 offset:2048
    ds_read_b64_tr_b16 v[114:115], v15 offset:2048
    ds_read_b64_tr_b16 v[52:53], v10 offset:2560
    ds_read_b64_tr_b16 v[54:55], v11 offset:2560
    ds_read_b64_tr_b16 v[84:85], v12 offset:2560
    ds_read_b64_tr_b16 v[86:87], v13 offset:2560
    ds_read_b64_tr_b16 v[116:117], v14 offset:2560
    ds_read_b64_tr_b16 v[118:119], v15 offset:2560
    ds_read_b64_tr_b16 v[56:57], v10 offset:3072
    ds_read_b64_tr_b16 v[58:59], v11 offset:3072
    ds_read_b64_tr_b16 v[88:89], v12 offset:3072
    ds_read_b64_tr_b16 v[90:91], v13 offset:3072
    ds_read_b64_tr_b16 v[120:121], v14 offset:3072
    ds_read_b64_tr_b16 v[122:123], v15 offset:3072
    ds_read_b64_tr_b16 v[60:61], v10 offset:3584
    ds_read_b64_tr_b16 v[62:63], v11 offset:3584
    ds_read_b64_tr_b16 v[92:93], v12 offset:3584
    ds_read_b64_tr_b16 v[94:95], v13 offset:3584
    ds_read_b64_tr_b16 v[124:125], v14 offset:3584
    ds_read_b64_tr_b16 v[126:127], v15 offset:3584
    s_waitcnt lgkmcnt(15)
    v_add_f32 v25, v25, v26
    s_add_u32 s56, s68, 1536
    v_mov_b32 v27, s56
    v_cvt_pk_bf16_f32 v25, v25, v25
    v_mfma_f32_16x16x32_bf16 v[128:131], v[32:35], v[64:67], v[20:23]
    v_mfma_f32_16x16x32_bf16 v[132:135], v[32:35], v[96:99], 0
    v_mfma_f32_16x16x32_bf16 v[128:131], v[36:39], v[68:71], v[128:131]
    v_mfma_f32_16x16x32_bf16 v[132:135], v[36:39], v[100:103], v[132:135]
    v_mfma_f32_16x16x32_bf16 v[128:131], v[40:43], v[72:75], v[128:131]
    v_mfma_f32_16x16x32_bf16 v[132:135], v[40:43], v[104:107], v[132:135]
    v_mfma_f32_16x16x32_bf16 v[128:131], v[44:47], v[76:79], v[128:131]
    v_mfma_f32_16x16x32_bf16 v[132:135], v[44:47], v[108:111], v[132:135]
    v_mfma_f32_16x16x32_bf16 v[128:131], v[48:51], v[80:83], v[128:131]
    v_mfma_f32_16x16x32_bf16 v[132:135], v[48:51], v[112:115], v[132:135]
    s_waitcnt lgkmcnt(14)
    v_mfma_f32_16x16x32_bf16 v[128:131], v[52:55], v[84:87], v[128:131]
    s_waitcnt lgkmcnt(12)
    v_mfma_f32_16x16x32_bf16 v[132:135], v[52:55], v[116:119], v[132:135]
    s_waitcnt lgkmcnt(8)
    v_mfma_f32_16x16x32_bf16 v[128:131], v[56:59], v[88:91], v[128:131]
    s_waitcnt lgkmcnt(6)
    v_mfma_f32_16x16x32_bf16 v[132:135], v[56:59], v[120:123], v[132:135]
    s_waitcnt lgkmcnt(2)
    v_mfma_f32_16x16x32_bf16 v[128:131], v[60:63], v[92:95], v[128:131]
    s_waitcnt lgkmcnt(0)
    v_mfma_f32_16x16x32_bf16 v[132:135], v[60:63], v[124:127], v[132:135]
    ds_write_b16 v27, v25
    v_lshlrev_b32 v2, 4, v1
    v_add_u32 v2, s68, v2
    s_lshl_b32 s56, s29, 8
    v_add_u32 v3, s56, v2
    v_add_u32 v4, 128, v3
    v_add_u32 v5, 512, v2
    v_add_u32 v6, 384, v2
    v_cmp_gt_u32 vcc, 16, v1
    s_cmp_eq_u32 s29, 1
    s_cselect_b64 s[70:71], vcc, 0
    v_cndmask_b32 v6, v5, v6, s[70:71]
    v_cmp_gt_u32 vcc, 8, v1
    s_nop 1
    v_cndmask_b32 v6, v6, v3, vcc
    v_cndmask_b32 v7, v5, v4, vcc
    s_cselect_b32 s56, 16, 32
    s_mov_b32 s72, 50462976
    s_mov_b32 s73, 84148994
    s_mov_b32 s74, 84148480
    s_cselect_b32 s69, s74, 16777472
    s_cselect_b32 s76, s73, s72
    v_mov_b32 v8, s72
    v_mov_b32 v9, s76
    v_cndmask_b32 v9, v9, v8, vcc
    v_mov_b32 v10, s74
    v_cmp_gt_u32 vcc, 32, v1
    s_nop 1
    v_cndmask_b32 v9, v10, v9, vcc
    v_cmp_gt_u32 vcc, s56, v1
    s_nop 1
    v_cndmask_b32 v11, v10, v8, vcc
    v_mov_b32 v12, s69
    v_cndmask_b32 v12, v12, v8, vcc
    v_cvt_pk_bf16_f32 v136, v128, v129
    v_cvt_pk_bf16_f32 v137, v130, v131
    v_cvt_pk_bf16_f32 v138, v132, v133
    v_cvt_pk_bf16_f32 v139, v134, v135
    ds_write_b64 v16, v[136:137]
    ds_write_b64 v17, v[138:139]
    s_waitcnt vmcnt(0)
    s_mov_b64 exec, s[66:67]
    v_cmp_ne_u64 vcc, s[44:45], v[254:255]
    s_mov_b64 exec, -1
    s_cbranch_vccz Qf1ok_5003
    s_mov_b32 s46, 8192
Qf1sp_5004:
    s_mov_b64 exec, s[66:67]
    buffer_load_dwordx2 v[254:255], v29, s[48:51], 0 offen sc1
    s_sub_u32 s46, s46, 1
    s_waitcnt vmcnt(0)
    v_cmp_ne_u64 vcc, s[44:45], v[254:255]
    s_mov_b64 exec, -1
    s_cbranch_vccz Qf1ok_5003
    s_cmp_lg_u32 s46, 0
    s_cbranch_scc1 Qf1sp_5004
Qf1ok_5003:
    buffer_load_dwordx4 v[224:227], v28, s[48:51], 0 offen sc1
    s_mov_b32 s56, 32768
    buffer_load_dwordx4 v[228:231], v28, s[48:51], s56 offen sc1
    v_lshlrev_b32 v64, 16, v248
    v_and_b32 v65, 0xffff0000, v248
    v_lshlrev_b32 v66, 16, v249
    v_and_b32 v67, 0xffff0000, v249
    v_lshlrev_b32 v68, 16, v250
    v_and_b32 v69, 0xffff0000, v250
    v_lshlrev_b32 v70, 16, v251
    v_and_b32 v71, 0xffff0000, v251
    v_lshlrev_b32 v72, 16, v240
    v_and_b32 v73, 0xffff0000, v240
    v_lshlrev_b32 v74, 16, v241
    v_and_b32 v75, 0xffff0000, v241
    v_lshlrev_b32 v76, 16, v242
    v_and_b32 v77, 0xffff0000, v242
    v_lshlrev_b32 v78, 16, v243
    v_and_b32 v79, 0xffff0000, v243
    v_mul_f32 v72, v72, v64
    v_mul_f32 v73, v73, v65
    v_mul_f32 v74, v74, v66
    v_mul_f32 v75, v75, v67
    v_mul_f32 v76, v76, v68
    v_mul_f32 v77, v77, v69
    v_mul_f32 v78, v78, v70
    v_mul_f32 v79, v79, v71
    v_cvt_pk_bf16_f32 v72, 0, v72
    v_cvt_pk_bf16_f32 v73, 0, v73
    v_cvt_pk_bf16_f32 v74, 0, v74
    v_cvt_pk_bf16_f32 v75, 0, v75
    v_cvt_pk_bf16_f32 v76, 0, v76
    v_cvt_pk_bf16_f32 v77, 0, v77
    v_cvt_pk_bf16_f32 v78, 0, v78
    v_cvt_pk_bf16_f32 v79, 0, v79
    v_add_f32 v72, v72, v76
    v_add_f32 v73, v73, v77
    v_add_f32 v74, v74, v78
    v_add_f32 v75, v75, v79
    v_add_f32 v72, v72, v74
    v_add_f32 v73, v73, v75
    v_add_f32 v72, v72, v73
    v_lshlrev_b32 v80, 16, v244
    v_and_b32 v81, 0xffff0000, v244
    v_lshlrev_b32 v82, 16, v245
    v_and_b32 v83, 0xffff0000, v245
    v_lshlrev_b32 v84, 16, v246
    v_and_b32 v85, 0xffff0000, v246
    v_lshlrev_b32 v86, 16, v247
    v_and_b32 v87, 0xffff0000, v247
    v_mul_f32 v80, v80, v64
    v_mul_f32 v81, v81, v65
    v_mul_f32 v82, v82, v66
    v_mul_f32 v83, v83, v67
    v_mul_f32 v84, v84, v68
    v_mul_f32 v85, v85, v69
    v_mul_f32 v86, v86, v70
    v_mul_f32 v87, v87, v71
    v_cvt_pk_bf16_f32 v80, 0, v80
    v_cvt_pk_bf16_f32 v81, 0, v81
    v_cvt_pk_bf16_f32 v82, 0, v82
    v_cvt_pk_bf16_f32 v83, 0, v83
    v_cvt_pk_bf16_f32 v84, 0, v84
    v_cvt_pk_bf16_f32 v85, 0, v85
    v_cvt_pk_bf16_f32 v86, 0, v86
    v_cvt_pk_bf16_f32 v87, 0, v87
    v_add_f32 v80, v80, v84
    v_add_f32 v81, v81, v85
    v_add_f32 v82, v82, v86
    v_add_f32 v83, v83, v87
    v_add_f32 v80, v80, v82
    v_add_f32 v81, v81, v83
    v_add_f32 v80, v80, v81
    s_nop 0
    v_add_f32_dpp v72, v72, v72 row_shr:1 row_mask:0xf bank_mask:0xf bound_ctrl:1
    v_add_f32_dpp v80, v80, v80 row_shr:1 row_mask:0xf bank_mask:0xf bound_ctrl:1
    s_nop 0
    v_add_f32_dpp v72, v72, v72 row_shr:2 row_mask:0xf bank_mask:0xf bound_ctrl:1
    v_add_f32_dpp v80, v80, v80 row_shr:2 row_mask:0xf bank_mask:0xf bound_ctrl:1
    s_nop 0
    v_add_f32_dpp v72, v72, v72 row_shr:4 row_mask:0xf bank_mask:0xf bound_ctrl:1
    v_add_f32_dpp v80, v80, v80 row_shr:4 row_mask:0xf bank_mask:0xf bound_ctrl:1
    s_nop 0
    v_add_f32_dpp v72, v72, v72 row_shr:8 row_mask:0xf bank_mask:0xf bound_ctrl:1
    v_add_f32_dpp v80, v80, v80 row_shr:8 row_mask:0xf bank_mask:0xf bound_ctrl:1
    s_nop 0
    v_add_f32_dpp v72, v72, v72 row_bcast:15 row_mask:0xa bank_mask:0xf
    v_add_f32_dpp v80, v80, v80 row_bcast:15 row_mask:0xa bank_mask:0xf
    s_nop 0
    v_add_f32_dpp v72, v72, v72 row_bcast:31 row_mask:0xc bank_mask:0xf
    v_add_f32_dpp v80, v80, v80 row_bcast:31 row_mask:0xc bank_mask:0xf
    s_mov_b32 s56, 3216550459
    v_cvt_pk_bf16_f32 v72, 0, v72
    v_cvt_pk_bf16_f32 v80, 0, v80
    v_mul_f32 v72, s56, v72
    v_mul_f32 v80, s56, v80
    v_exp_f32 v72, v72
    v_exp_f32 v80, v80
    s_nop 0
    v_add_f32 v72, 1.0, v72
    v_add_f32 v80, 1.0, v80
    v_rcp_f32 v72, v72
    v_rcp_f32 v80, v80
    s_nop 0
    v_cvt_pk_bf16_f32 v88, 0, v72
    v_cvt_pk_bf16_f32 v90, 0, v80
    v_sub_f32 v89, 1.0, v88
    v_sub_f32 v91, 1.0, v90
    v_cvt_pk_bf16_f32 v89, 0, v89
    v_cvt_pk_bf16_f32 v91, 0, v91
    s_lshl_b32 s56, s30, 3
    s_add_u32 s56, s56, 5767168
    v_mov_b32 v92, s56
    s_lshl_b64 exec, 1, 63
    buffer_store_dwordx4 v[88:91], v92, s[48:51], 0 offen sc1
    s_mov_b64 exec, -1
    v_lshlrev_b32 v253, 4, v1
    s_lshl_b32 s56, s47, 12
    s_lshl_b32 s57, s29, 11
    s_add_u32 s56, s56, s57
    s_add_u32 s56, s56, 12582912
    v_add_u32 v232, s56, v253
    s_lshl_b32 s56, s31, 2
    s_lshl_b32 s57, s29, 1
    s_add_u32 s56, s56, s57
    s_mul_i32 s56, s56, 1280
    s_add_u32 s77, s56, 42240
    v_add_u32 v242, s77, v253
    v_bfe_u32 v248, v1, 4, 1
    v_mul_u32_u24 v248, 1280, v248
    v_and_b32 v243, 15, v1
    v_lshlrev_b32 v249, 4, v243
    v_add3_u32 v233, v248, v249, s77
    v_mov_b32 v244, 0
    v_mov_b32 v245, 0
    v_mov_b32 v246, 0
    v_mov_b32 v247, 0
    s_mul_i32 s58, s31, 21120
    s_mul_i32 s57, s29, 2112
    s_add_u32 s56, s58, s57
    v_add_u32 v234, s56, v253
    v_lshrrev_b32 v252, 4, v1
    s_lshl_b32 s57, s29, 1
    s_sub_u32 s57, 4, s57
    v_add_u32 v248, s57, v243
    v_mul_u32_u24 v248, 1056, v248
    v_lshlrev_b32 v249, 4, v252
    v_add3_u32 v240, v248, v249, s58
    v_subrev_u32 v241, 1056, v240
    v_sub_u32 v248, v252, v243
    v_add_u32 v248, 15, v248
    v_lshlrev_b32 v248, 4, v248
    v_add_u32 v235, s77, v248
    v_and_b32 v248, 3, v243
    v_lshlrev_b32 v248, 1, v248
    v_bfe_u32 v249, v243, 2, 1
    v_or_b32 v248, v248, v249
    v_xor_b32 v248, v248, v252
    v_lshlrev_b32 v248, 4, v248
    v_lshlrev_b32 v249, 7, v243
    s_lshl_b32 s56, s28, 13
    v_add3_u32 v236, v248, v249, s56
    v_xor_b32 v237, 64, v236
    v_lshrrev_b32 v248, 2, v1
    v_and_b32 v249, 3, v248
    v_lshlrev_b32 v249, 1, v249
    v_bfe_u32 v250, v248, 2, 1
    v_or_b32 v249, v249, v250
    v_and_b32 v250, 3, v1
    v_lshlrev_b32 v250, 1, v250
    v_xor_b32 v249, v249, v250
    v_lshlrev_b32 v249, 4, v249
    v_lshlrev_b32 v248, 7, v248
    s_lshl_b32 s56, s31, 14
    s_lshl_b32 s57, s29, 12
    s_add_u32 s56, s56, s57
    v_add3_u32 v238, v248, v249, s56
    v_xor_b32 v239, 16, v238
    s_waitcnt lgkmcnt(0)
    s_barrier
    ds_read_b128 v[32:35], v6
    ds_read_b32 v36, v6 offset:16
    ds_read_b128 v[40:43], v7
    ds_read_b32 v44, v7 offset:16
    ds_write_b128 v233, v[244:247] offset:1024
    s_waitcnt lgkmcnt(3)
    v_perm_b32 v48, v33, v32, v12
    v_perm_b32 v49, v34, v33, v11
    v_perm_b32 v50, v35, v34, v12
    v_perm_b32 v51, v36, v35, v11
    s_nop 1
    v_mov_b32_dpp v46, v50 wave_shr:1 row_mask:0xf bank_mask:0xf bound_ctrl:1
    v_mov_b32_dpp v47, v51 wave_shr:1 row_mask:0xf bank_mask:0xf bound_ctrl:1
    ds_write_b128 v234, v[48:51] offset:16896
    v_alignbit_b32 v64, v48, v47, 16
    v_alignbit_b32 v65, v49, v48, 16
    v_alignbit_b32 v66, v50, v49, 16
    v_alignbit_b32 v67, v51, v50, 16
    ds_write_b128 v234, v[64:67] offset:12672
    v_mov_b32 v68, v47
    v_mov_b32 v69, v48
    v_mov_b32 v70, v49
    v_mov_b32 v71, v50
    ds_write_b128 v234, v[68:71] offset:8448
    v_alignbit_b32 v72, v47, v46, 16
    v_alignbit_b32 v73, v48, v47, 16
    v_alignbit_b32 v74, v49, v48, 16
    v_alignbit_b32 v75, v50, v49, 16
    ds_write_b128 v234, v[72:75] offset:4224
    ds_write_b128 v234, v[46:49] offset:0
    s_waitcnt lgkmcnt(6)
    v_perm_b32 v54, v41, v40, v9
    v_perm_b32 v55, v42, v41, v9
    v_perm_b32 v56, v43, v42, v9
    v_perm_b32 v57, v44, v43, v9
    s_nop 1
    v_mov_b32_dpp v52, v56 wave_shr:1 row_mask:0xf bank_mask:0xf bound_ctrl:1
    v_mov_b32_dpp v53, v57 wave_shr:1 row_mask:0xf bank_mask:0xf bound_ctrl:1
    ds_write_b128 v234, v[54:57] offset:17952
    v_alignbit_b32 v76, v54, v53, 16
    v_alignbit_b32 v77, v55, v54, 16
    v_alignbit_b32 v78, v56, v55, 16
    v_alignbit_b32 v79, v57, v56, 16
    ds_write_b128 v234, v[76:79] offset:13728
    v_mov_b32 v80, v53
    v_mov_b32 v81, v54
    v_mov_b32 v82, v55
    v_mov_b32 v83, v56
    ds_write_b128 v234, v[80:83] offset:9504
    v_alignbit_b32 v84, v53, v52, 16
    v_alignbit_b32 v85, v54, v53, 16
    v_alignbit_b32 v86, v55, v54, 16
    v_alignbit_b32 v87, v56, v55, 16
    ds_write_b128 v234, v[84:87] offset:5280
    ds_write_b128 v234, v[52:55] offset:1056
    s_waitcnt vmcnt(1)
    ds_write_b128 v242, v[224:227]
    ds_write_b128 v242, v[228:231] offset:1280
    s_waitcnt lgkmcnt(0)
    s_barrier
    s_setprio 1
    ds_read_b128 v[64:67], v240 offset:0
    ds_read_b128 v[192:195], v235 offset:0
    ds_read_b64 v[196:197], v235 offset:16
    ds_read_b128 v[68:71], v240 offset:64
    ds_read_b128 v[198:201], v235 offset:64
    ds_read_b64 v[202:203], v235 offset:80
    ds_read_b128 v[72:75], v240 offset:128
    ds_read_b128 v[204:207], v235 offset:128
    ds_read_b64 v[208:209], v235 offset:144
    ds_read_b128 v[76:79], v240 offset:192
    ds_read_b128 v[210:213], v235 offset:192
    ds_read_b64 v[214:215], v235 offset:208
    s_waitcnt lgkmcnt(9)
    v_mfma_f32_16x16x32_bf16 v[60:63], v[64:67], v[192:195], 0
    ds_read_b128 v[80:83], v240 offset:256
    ds_read_b128 v[216:219], v235 offset:256
    ds_read_b64 v[220:221], v235 offset:272
    v_mfma_f32_16x16x32_bf16 v[56:59], v[64:67], v[194:197], 0
    s_waitcnt lgkmcnt(9)
    v_mfma_f32_16x16x32_bf16 v[60:63], v[68:71], v[198:201], v[60:63]
    ds_read_b128 v[84:87], v240 offset:320
    ds_read_b128 v[192:195], v235 offset:320
    ds_read_b64 v[196:197], v235 offset:336
    v_mfma_f32_16x16x32_bf16 v[56:59], v[68:71], v[200:203], v[56:59]
    s_waitcnt lgkmcnt(9)
    v_mfma_f32_16x16x32_bf16 v[60:63], v[72:75], v[204:207], v[60:63]
    ds_read_b128 v[88:91], v240 offset:384
    ds_read_b128 v[198:201], v235 offset:384
    ds_read_b64 v[202:203], v235 offset:400
    v_mfma_f32_16x16x32_bf16 v[56:59], v[72:75], v[206:209], v[56:59]
    s_waitcnt lgkmcnt(9)
    v_mfma_f32_16x16x32_bf16 v[60:63], v[76:79], v[210:213], v[60:63]
    ds_read_b128 v[92:95], v240 offset:448
    ds_read_b128 v[204:207], v235 offset:448
    ds_read_b64 v[208:209], v235 offset:464
    v_mfma_f32_16x16x32_bf16 v[56:59], v[76:79], v[212:215], v[56:59]
    s_waitcnt lgkmcnt(9)
    v_mfma_f32_16x16x32_bf16 v[60:63], v[80:83], v[216:219], v[60:63]
    ds_read_b128 v[96:99], v240 offset:512
    ds_read_b128 v[210:213], v235 offset:512
    ds_read_b64 v[214:215], v235 offset:528
    v_mfma_f32_16x16x32_bf16 v[56:59], v[80:83], v[218:221], v[56:59]
    v_mfma_f32_16x16x32_bf16 v[52:55], v[64:67], v[216:219], 0
    v_mfma_f32_16x16x32_bf16 v[48:51], v[64:67], v[218:221], 0
    s_waitcnt lgkmcnt(9)
    v_mfma_f32_16x16x32_bf16 v[60:63], v[84:87], v[192:195], v[60:63]
    ds_read_b128 v[100:103], v240 offset:576
    ds_read_b128 v[216:219], v235 offset:576
    ds_read_b64 v[220:221], v235 offset:592
    v_mfma_f32_16x16x32_bf16 v[56:59], v[84:87], v[194:197], v[56:59]
    v_mfma_f32_16x16x32_bf16 v[52:55], v[68:71], v[192:195], v[52:55]
    v_mfma_f32_16x16x32_bf16 v[48:51], v[68:71], v[194:197], v[48:51]
    s_waitcnt lgkmcnt(9)
    v_mfma_f32_16x16x32_bf16 v[60:63], v[88:91], v[198:201], v[60:63]
    ds_read_b128 v[104:107], v240 offset:640
    ds_read_b128 v[192:195], v235 offset:640
    ds_read_b64 v[196:197], v235 offset:656
    v_mfma_f32_16x16x32_bf16 v[56:59], v[88:91], v[200:203], v[56:59]
    v_mfma_f32_16x16x32_bf16 v[52:55], v[72:75], v[198:201], v[52:55]
    v_mfma_f32_16x16x32_bf16 v[48:51], v[72:75], v[200:203], v[48:51]
    s_waitcnt lgkmcnt(9)
    v_mfma_f32_16x16x32_bf16 v[60:63], v[92:95], v[204:207], v[60:63]
    ds_read_b128 v[108:111], v240 offset:704
    ds_read_b128 v[198:201], v235 offset:704
    ds_read_b64 v[202:203], v235 offset:720
    v_mfma_f32_16x16x32_bf16 v[56:59], v[92:95], v[206:209], v[56:59]
    v_mfma_f32_16x16x32_bf16 v[52:55], v[76:79], v[204:207], v[52:55]
    v_mfma_f32_16x16x32_bf16 v[48:51], v[76:79], v[206:209], v[48:51]
    s_waitcnt lgkmcnt(9)
    v_mfma_f32_16x16x32_bf16 v[60:63], v[96:99], v[210:213], v[60:63]
    ds_read_b128 v[112:115], v240 offset:768
    ds_read_b128 v[204:207], v235 offset:768
    ds_read_b64 v[208:209], v235 offset:784
    v_mfma_f32_16x16x32_bf16 v[56:59], v[96:99], v[212:215], v[56:59]
    v_mfma_f32_16x16x32_bf16 v[52:55], v[80:83], v[210:213], v[52:55]
    v_mfma_f32_16x16x32_bf16 v[48:51], v[80:83], v[212:215], v[48:51]
    v_mfma_f32_16x16x32_bf16 v[44:47], v[64:67], v[210:213], 0
    v_mfma_f32_16x16x32_bf16 v[40:43], v[64:67], v[212:215], 0
    s_waitcnt lgkmcnt(9)
    v_mfma_f32_16x16x32_bf16 v[60:63], v[100:103], v[216:219], v[60:63]
    ds_read_b128 v[116:119], v240 offset:832
    ds_read_b128 v[210:213], v235 offset:832
    ds_read_b64 v[214:215], v235 offset:848
    v_mfma_f32_16x16x32_bf16 v[56:59], v[100:103], v[218:221], v[56:59]
    v_mfma_f32_16x16x32_bf16 v[52:55], v[84:87], v[216:219], v[52:55]
    v_mfma_f32_16x16x32_bf16 v[48:51], v[84:87], v[218:221], v[48:51]
    v_mfma_f32_16x16x32_bf16 v[44:47], v[68:71], v[216:219], v[44:47]
    v_mfma_f32_16x16x32_bf16 v[40:43], v[68:71], v[218:221], v[40:43]
    s_waitcnt lgkmcnt(9)
    v_mfma_f32_16x16x32_bf16 v[60:63], v[104:107], v[192:195], v[60:63]
    ds_read_b128 v[120:123], v240 offset:896
    ds_read_b128 v[216:219], v235 offset:896
    ds_read_b64 v[220:221], v235 offset:912
    v_mfma_f32_16x16x32_bf16 v[56:59], v[104:107], v[194:197], v[56:59]
    v_mfma_f32_16x16x32_bf16 v[52:55], v[88:91], v[192:195], v[52:55]
    v_mfma_f32_16x16x32_bf16 v[48:51], v[88:91], v[194:197], v[48:51]
    v_mfma_f32_16x16x32_bf16 v[44:47], v[72:75], v[192:195], v[44:47]
    v_mfma_f32_16x16x32_bf16 v[40:43], v[72:75], v[194:197], v[40:43]
    s_waitcnt lgkmcnt(9)
    v_mfma_f32_16x16x32_bf16 v[60:63], v[108:111], v[198:201], v[60:63]
    ds_read_b128 v[124:127], v240 offset:960
    ds_read_b128 v[192:195], v235 offset:960
    ds_read_b64 v[196:197], v235 offset:976
    v_mfma_f32_16x16x32_bf16 v[56:59], v[108:111], v[200:203], v[56:59]
    v_mfma_f32_16x16x32_bf16 v[52:55], v[92:95], v[198:201], v[52:55]
    v_mfma_f32_16x16x32_bf16 v[48:51], v[92:95], v[200:203], v[48:51]
    v_mfma_f32_16x16x32_bf16 v[44:47], v[76:79], v[198:201], v[44:47]
    v_mfma_f32_16x16x32_bf16 v[40:43], v[76:79], v[200:203], v[40:43]
    s_waitcnt lgkmcnt(9)
    v_mfma_f32_16x16x32_bf16 v[60:63], v[112:115], v[204:207], v[60:63]
    ds_read_b128 v[128:131], v241 offset:0
    ds_read_b128 v[198:201], v235 offset:1280
    ds_read_b64 v[202:203], v235 offset:1296
    v_mfma_f32_16x16x32_bf16 v[56:59], v[112:115], v[206:209], v[56:59]
    v_mfma_f32_16x16x32_bf16 v[52:55], v[96:99], v[204:207], v[52:55]
    v_mfma_f32_16x16x32_bf16 v[48:51], v[96:99], v[206:209], v[48:51]
    v_mfma_f32_16x16x32_bf16 v[44:47], v[80:83], v[204:207], v[44:47]
    v_mfma_f32_16x16x32_bf16 v[40:43], v[80:83], v[206:209], v[40:43]
    v_mfma_f32_16x16x32_bf16 v[36:39], v[64:67], v[204:207], 0
    v_mfma_f32_16x16x32_bf16 v[32:35], v[64:67], v[206:209], 0
    s_waitcnt lgkmcnt(9)
    v_mfma_f32_16x16x32_bf16 v[60:63], v[116:119], v[210:213], v[60:63]
    ds_read_b128 v[132:135], v241 offset:64
    ds_read_b128 v[204:207], v235 offset:1344
    ds_read_b64 v[208:209], v235 offset:1360
    v_mfma_f32_16x16x32_bf16 v[56:59], v[116:119], v[212:215], v[56:59]
    v_mfma_f32_16x16x32_bf16 v[52:55], v[100:103], v[210:213], v[52:55]
    v_mfma_f32_16x16x32_bf16 v[48:51], v[100:103], v[212:215], v[48:51]
    v_mfma_f32_16x16x32_bf16 v[44:47], v[84:87], v[210:213], v[44:47]
    v_mfma_f32_16x16x32_bf16 v[40:43], v[84:87], v[212:215], v[40:43]
    v_mfma_f32_16x16x32_bf16 v[36:39], v[68:71], v[210:213], v[36:39]
    v_mfma_f32_16x16x32_bf16 v[32:35], v[68:71], v[212:215], v[32:35]
    s_waitcnt lgkmcnt(9)
    v_mfma_f32_16x16x32_bf16 v[60:63], v[120:123], v[216:219], v[60:63]
    ds_read_b128 v[136:139], v241 offset:128
    ds_read_b128 v[210:213], v235 offset:1408
    ds_read_b64 v[214:215], v235 offset:1424
    v_mfma_f32_16x16x32_bf16 v[56:59], v[120:123], v[218:221], v[56:59]
    v_mfma_f32_16x16x32_bf16 v[52:55], v[104:107], v[216:219], v[52:55]
    v_mfma_f32_16x16x32_bf16 v[48:51], v[104:107], v[218:221], v[48:51]
    v_mfma_f32_16x16x32_bf16 v[44:47], v[88:91], v[216:219], v[44:47]
    v_mfma_f32_16x16x32_bf16 v[40:43], v[88:91], v[218:221], v[40:43]
    v_mfma_f32_16x16x32_bf16 v[36:39], v[72:75], v[216:219], v[36:39]
    v_mfma_f32_16x16x32_bf16 v[32:35], v[72:75], v[218:221], v[32:35]
    s_waitcnt lgkmcnt(9)
    v_mfma_f32_16x16x32_bf16 v[60:63], v[124:127], v[192:195], v[60:63]
    ds_read_b128 v[140:143], v241 offset:192
    ds_read_b128 v[216:219], v235 offset:1472
    ds_read_b64 v[220:221], v235 offset:1488
    v_mfma_f32_16x16x32_bf16 v[56:59], v[124:127], v[194:197], v[56:59]
    v_mfma_f32_16x16x32_bf16 v[52:55], v[108:111], v[192:195], v[52:55]
    v_mfma_f32_16x16x32_bf16 v[48:51], v[108:111], v[194:197], v[48:51]
    v_mfma_f32_16x16x32_bf16 v[44:47], v[92:95], v[192:195], v[44:47]
    v_mfma_f32_16x16x32_bf16 v[40:43], v[92:95], v[194:197], v[40:43]
    v_mfma_f32_16x16x32_bf16 v[36:39], v[76:79], v[192:195], v[36:39]
    v_mfma_f32_16x16x32_bf16 v[32:35], v[76:79], v[194:197], v[32:35]
    s_waitcnt lgkmcnt(9)
    v_mfma_f32_16x16x32_bf16 v[60:63], v[128:131], v[198:201], v[60:63]
    ds_read_b128 v[144:147], v241 offset:256
    ds_read_b128 v[192:195], v235 offset:1536
    ds_read_b64 v[196:197], v235 offset:1552
    v_mfma_f32_16x16x32_bf16 v[56:59], v[128:131], v[200:203], v[56:59]
    s_waitcnt lgkmcnt(9)
    v_mfma_f32_16x16x32_bf16 v[60:63], v[132:135], v[204:207], v[60:63]
    ds_read_b128 v[148:151], v241 offset:320
    ds_read_b128 v[198:201], v235 offset:1600
    ds_read_b64 v[202:203], v235 offset:1616
    v_mfma_f32_16x16x32_bf16 v[56:59], v[132:135], v[206:209], v[56:59]
    s_waitcnt lgkmcnt(9)
    v_mfma_f32_16x16x32_bf16 v[60:63], v[136:139], v[210:213], v[60:63]
    ds_read_b128 v[152:155], v241 offset:384
    ds_read_b128 v[204:207], v235 offset:1664
    ds_read_b64 v[208:209], v235 offset:1680
    v_mfma_f32_16x16x32_bf16 v[56:59], v[136:139], v[212:215], v[56:59]
    s_waitcnt lgkmcnt(9)
    v_mfma_f32_16x16x32_bf16 v[60:63], v[140:143], v[216:219], v[60:63]
    ds_read_b128 v[156:159], v241 offset:448
    ds_read_b128 v[210:213], v235 offset:1728
    ds_read_b64 v[214:215], v235 offset:1744
    v_mfma_f32_16x16x32_bf16 v[56:59], v[140:143], v[218:221], v[56:59]
    s_waitcnt lgkmcnt(9)
    v_mfma_f32_16x16x32_bf16 v[60:63], v[144:147], v[192:195], v[60:63]
    ds_read_b128 v[160:163], v241 offset:512
    ds_read_b128 v[216:219], v235 offset:1792
    ds_read_b64 v[220:221], v235 offset:1808
    v_mfma_f32_16x16x32_bf16 v[56:59], v[144:147], v[194:197], v[56:59]
    v_mfma_f32_16x16x32_bf16 v[52:55], v[128:131], v[192:195], v[52:55]
    v_mfma_f32_16x16x32_bf16 v[48:51], v[128:131], v[194:197], v[48:51]
    s_waitcnt lgkmcnt(9)
    v_mfma_f32_16x16x32_bf16 v[60:63], v[148:151], v[198:201], v[60:63]
    ds_read_b128 v[164:167], v241 offset:576
    ds_read_b128 v[192:195], v235 offset:1856
    ds_read_b64 v[196:197], v235 offset:1872
    v_mfma_f32_16x16x32_bf16 v[56:59], v[148:151], v[200:203], v[56:59]
    v_mfma_f32_16x16x32_bf16 v[52:55], v[132:135], v[198:201], v[52:55]
    v_mfma_f32_16x16x32_bf16 v[48:51], v[132:135], v[200:203], v[48:51]
    s_waitcnt lgkmcnt(9)
    v_mfma_f32_16x16x32_bf16 v[60:63], v[152:155], v[204:207], v[60:63]
    ds_read_b128 v[168:171], v241 offset:640
    ds_read_b128 v[198:201], v235 offset:1920
    ds_read_b64 v[202:203], v235 offset:1936
    v_mfma_f32_16x16x32_bf16 v[56:59], v[152:155], v[206:209], v[56:59]
    v_mfma_f32_16x16x32_bf16 v[52:55], v[136:139], v[204:207], v[52:55]
    v_mfma_f32_16x16x32_bf16 v[48:51], v[136:139], v[206:209], v[48:51]
    s_waitcnt lgkmcnt(9)
    v_mfma_f32_16x16x32_bf16 v[60:63], v[156:159], v[210:213], v[60:63]
    ds_read_b128 v[172:175], v241 offset:704
    ds_read_b128 v[204:207], v235 offset:1984
    ds_read_b64 v[208:209], v235 offset:2000
    v_mfma_f32_16x16x32_bf16 v[56:59], v[156:159], v[212:215], v[56:59]
    v_mfma_f32_16x16x32_bf16 v[52:55], v[140:143], v[210:213], v[52:55]
    v_mfma_f32_16x16x32_bf16 v[48:51], v[140:143], v[212:215], v[48:51]
    s_waitcnt lgkmcnt(9)
    v_mfma_f32_16x16x32_bf16 v[60:63], v[160:163], v[216:219], v[60:63]
    ds_read_b128 v[176:179], v241 offset:768
    ds_read_b128 v[210:213], v235 offset:2048
    ds_read_b64 v[214:215], v235 offset:2064
    v_mfma_f32_16x16x32_bf16 v[56:59], v[160:163], v[218:221], v[56:59]
    v_mfma_f32_16x16x32_bf16 v[52:55], v[144:147], v[216:219], v[52:55]
    v_mfma_f32_16x16x32_bf16 v[48:51], v[144:147], v[218:221], v[48:51]
    v_mfma_f32_16x16x32_bf16 v[44:47], v[128:131], v[216:219], v[44:47]
    v_mfma_f32_16x16x32_bf16 v[40:43], v[128:131], v[218:221], v[40:43]
    s_waitcnt lgkmcnt(9)
    v_mfma_f32_16x16x32_bf16 v[60:63], v[164:167], v[192:195], v[60:63]
    ds_read_b128 v[180:183], v241 offset:832
    ds_read_b128 v[216:219], v235 offset:2112
    ds_read_b64 v[220:221], v235 offset:2128
    v_mfma_f32_16x16x32_bf16 v[56:59], v[164:167], v[194:197], v[56:59]
    v_mfma_f32_16x16x32_bf16 v[52:55], v[148:151], v[192:195], v[52:55]
    v_mfma_f32_16x16x32_bf16 v[48:51], v[148:151], v[194:197], v[48:51]
    v_mfma_f32_16x16x32_bf16 v[44:47], v[132:135], v[192:195], v[44:47]
    v_mfma_f32_16x16x32_bf16 v[40:43], v[132:135], v[194:197], v[40:43]
    s_waitcnt lgkmcnt(9)
    v_mfma_f32_16x16x32_bf16 v[60:63], v[168:171], v[198:201], v[60:63]
    ds_read_b128 v[184:187], v241 offset:896
    ds_read_b128 v[192:195], v235 offset:2176
    ds_read_b64 v[196:197], v235 offset:2192
    v_mfma_f32_16x16x32_bf16 v[56:59], v[168:171], v[200:203], v[56:59]
    v_mfma_f32_16x16x32_bf16 v[52:55], v[152:155], v[198:201], v[52:55]
    v_mfma_f32_16x16x32_bf16 v[48:51], v[152:155], v[200:203], v[48:51]
    v_mfma_f32_16x16x32_bf16 v[44:47], v[136:139], v[198:201], v[44:47]
    v_mfma_f32_16x16x32_bf16 v[40:43], v[136:139], v[200:203], v[40:43]
    s_waitcnt lgkmcnt(9)
    v_mfma_f32_16x16x32_bf16 v[60:63], v[172:175], v[204:207], v[60:63]
    ds_read_b128 v[188:191], v241 offset:960
    ds_read_b128 v[198:201], v235 offset:2240
    ds_read_b64 v[202:203], v235 offset:2256
    v_mfma_f32_16x16x32_bf16 v[56:59], v[172:175], v[206:209], v[56:59]
    v_mfma_f32_16x16x32_bf16 v[52:55], v[156:159], v[204:207], v[52:55]
    v_mfma_f32_16x16x32_bf16 v[48:51], v[156:159], v[206:209], v[48:51]
    v_mfma_f32_16x16x32_bf16 v[44:47], v[140:143], v[204:207], v[44:47]
    v_mfma_f32_16x16x32_bf16 v[40:43], v[140:143], v[206:209], v[40:43]
    s_waitcnt lgkmcnt(9)
    v_mfma_f32_16x16x32_bf16 v[60:63], v[176:179], v[210:213], v[60:63]
    v_mfma_f32_16x16x32_bf16 v[56:59], v[176:179], v[212:215], v[56:59]
    v_mfma_f32_16x16x32_bf16 v[52:55], v[160:163], v[210:213], v[52:55]
    v_mfma_f32_16x16x32_bf16 v[48:51], v[160:163], v[212:215], v[48:51]
    v_mfma_f32_16x16x32_bf16 v[44:47], v[144:147], v[210:213], v[44:47]
    v_mfma_f32_16x16x32_bf16 v[40:43], v[144:147], v[212:215], v[40:43]
    v_mfma_f32_16x16x32_bf16 v[36:39], v[128:131], v[210:213], v[36:39]
    v_mfma_f32_16x16x32_bf16 v[32:35], v[128:131], v[212:215], v[32:35]
    s_waitcnt lgkmcnt(6)
    v_mfma_f32_16x16x32_bf16 v[60:63], v[180:183], v[216:219], v[60:63]
    v_mfma_f32_16x16x32_bf16 v[56:59], v[180:183], v[218:221], v[56:59]
    v_mfma_f32_16x16x32_bf16 v[52:55], v[164:167], v[216:219], v[52:55]
    v_mfma_f32_16x16x32_bf16 v[48:51], v[164:167], v[218:221], v[48:51]
    v_mfma_f32_16x16x32_bf16 v[44:47], v[148:151], v[216:219], v[44:47]
    v_mfma_f32_16x16x32_bf16 v[40:43], v[148:151], v[218:221], v[40:43]
    v_mfma_f32_16x16x32_bf16 v[36:39], v[132:135], v[216:219], v[36:39]
    v_mfma_f32_16x16x32_bf16 v[32:35], v[132:135], v[218:221], v[32:35]
    s_waitcnt lgkmcnt(3)
    v_mfma_f32_16x16x32_bf16 v[60:63], v[184:187], v[192:195], v[60:63]
    v_mfma_f32_16x16x32_bf16 v[56:59], v[184:187], v[194:197], v[56:59]
    v_mfma_f32_16x16x32_bf16 v[52:55], v[168:171], v[192:195], v[52:55]
    v_mfma_f32_16x16x32_bf16 v[48:51], v[168:171], v[194:197], v[48:51]
    v_mfma_f32_16x16x32_bf16 v[44:47], v[152:155], v[192:195], v[44:47]
    v_mfma_f32_16x16x32_bf16 v[40:43], v[152:155], v[194:197], v[40:43]
    v_mfma_f32_16x16x32_bf16 v[36:39], v[136:139], v[192:195], v[36:39]
    v_mfma_f32_16x16x32_bf16 v[32:35], v[136:139], v[194:197], v[32:35]
    s_waitcnt lgkmcnt(0)
    v_mfma_f32_16x16x32_bf16 v[60:63], v[188:191], v[198:201], v[60:63]
    v_mfma_f32_16x16x32_bf16 v[56:59], v[188:191], v[200:203], v[56:59]
    v_mfma_f32_16x16x32_bf16 v[52:55], v[172:175], v[198:201], v[52:55]
    v_mfma_f32_16x16x32_bf16 v[48:51], v[172:175], v[200:203], v[48:51]
    v_mfma_f32_16x16x32_bf16 v[44:47], v[156:159], v[198:201], v[44:47]
    v_mfma_f32_16x16x32_bf16 v[40:43], v[156:159], v[200:203], v[40:43]
    v_mfma_f32_16x16x32_bf16 v[36:39], v[140:143], v[198:201], v[36:39]
    v_mfma_f32_16x16x32_bf16 v[32:35], v[140:143], v[200:203], v[32:35]
    s_setprio 0
    s_barrier
    ds_write_b128 v237, v[60:63] offset:6144
    ds_write_b128 v236, v[56:59] offset:6144
    ds_write_b128 v237, v[52:55] offset:4096
    ds_write_b128 v236, v[48:51] offset:4096
    ds_write_b128 v237, v[44:47] offset:2048
    ds_write_b128 v236, v[40:43] offset:2048
    ds_write_b128 v237, v[36:39] offset:0
    ds_write_b128 v236, v[32:35] offset:0
    s_waitcnt lgkmcnt(0)
    s_barrier
    ds_read_b128 v[64:67], v238 offset:0
    ds_read_b128 v[68:71], v239 offset:0
    ds_read_b128 v[72:75], v238 offset:8192
    ds_read_b128 v[76:79], v239 offset:8192
    ds_read_b128 v[80:83], v238 offset:2048
    ds_read_b128 v[84:87], v239 offset:2048
    ds_read_b128 v[88:91], v238 offset:10240
    ds_read_b128 v[92:95], v239 offset:10240
    s_waitcnt lgkmcnt(4)
    v_add_f32 v64, v64, v72
    v_add_f32 v65, v65, v73
    v_add_f32 v66, v66, v74
    v_add_f32 v67, v67, v75
    v_add_f32 v68, v68, v76
    v_add_f32 v69, v69, v77
    v_add_f32 v70, v70, v78
    v_add_f32 v71, v71, v79
    v_cvt_pk_bf16_f32 v72, v64, v65
    v_cvt_pk_bf16_f32 v73, v66, v67
    v_cvt_pk_bf16_f32 v74, v68, v69
    v_cvt_pk_bf16_f32 v75, v70, v71
    buffer_store_dwordx4 v[72:75], v232, s[48:51], 0 offen offset:0 sc1
    s_waitcnt lgkmcnt(0)
    v_add_f32 v80, v80, v88
    v_add_f32 v81, v81, v89
    v_add_f32 v82, v82, v90
    v_add_f32 v83, v83, v91
    v_add_f32 v84, v84, v92
    v_add_f32 v85, v85, v93
    v_add_f32 v86, v86, v94
    v_add_f32 v87, v87, v95
    v_cvt_pk_bf16_f32 v88, v80, v81
    v_cvt_pk_bf16_f32 v89, v82, v83
    v_cvt_pk_bf16_f32 v90, v84, v85
    v_cvt_pk_bf16_f32 v91, v86, v87
    buffer_store_dwordx4 v[88:91], v232, s[48:51], 0 offen offset:1024 sc1
    s_waitcnt vmcnt(0)
    s_barrier
    s_cmp_lg_u32 s28, 0
    s_cbranch_scc1 CVdone_5005
    s_lshl_b32 s56, s3, 7
    s_add_u32 s56, s56, 5799936
    v_mov_b32 v2, s56
    v_mov_b32 v4, s44
    v_mov_b32 v5, s45
    s_mov_b64 exec, 1
    buffer_store_dwordx2 v[4:5], v2, s[48:51], 0 offen sc1
    s_mov_b64 exec, -1
CVdone_5005:
L_end:
    s_endpgm
.section .rodata,"a"
.p2align 6
.amdhsa_kernel gated_mix__ssm_conv_s4__glu_gated_reglu__prompt_kernel
  .amdhsa_next_free_vgpr 256
  .amdhsa_next_free_sgpr 102
  .amdhsa_accum_offset 256
  .amdhsa_group_segment_fixed_size 0
  .amdhsa_kernarg_size 136
  .amdhsa_user_sgpr_count 2
  .amdhsa_user_sgpr_kernarg_segment_ptr 1
  .amdhsa_system_sgpr_workgroup_id_x 1
.end_amdhsa_kernel
```
